```python
import torch

def _softmax(x, axis=-1):
    return torch.softmax(x, dim=axis)
def _gelu(x):
    return torch.nn.functional.gelu(x, approximate="tanh")
def _silu(x):
    return torch.nn.functional.silu(x)
def _sigmoid(x):
    return torch.sigmoid(x)
def _layernorm(x, axis=-1, eps=1e-5):
    m = x.mean(dim=axis, keepdim=True)
    v = x.var(dim=axis, keepdim=True, unbiased=False)
    return (x - m) / torch.sqrt(v + eps)
def _scatter_add(tgt, idx, src, axis=0):
    return tgt.clone().index_add_(axis, idx, src)
def _segment_sum(src, seg, n):
    out = torch.zeros((n,) + src.shape[1:], dtype=src.dtype)
    return out.index_add_(0, seg, src)
def _pad(x, pw):
    flat = tuple(v for pair in reversed(pw) for v in pair)
    return torch.nn.functional.pad(x, flat)

kernel_name = 'gated_mix__spectral_fnet__glu_gated_glu__prompt'

def setup_inputs():

    _w = (lambda a: (lambda t: t.to(torch.bfloat16) if t.is_floating_point() else t)(torch.as_tensor(a)))
    def _A_setup():
        B, S, D = 1, 2048, 512
        ns = torch.arange(S)[:, None] * torch.arange(S)[None, :]
        nd = torch.arange(D)[:, None] * torch.arange(D)[None, :]
        Ws_re = torch.cos(-2.0 * torch.pi * ns / S).to(float)
        Ws_im = torch.sin(-2.0 * torch.pi * ns / S).to(float)
        Wd_re = torch.cos(-2.0 * torch.pi * nd / D).to(float)
        Wd_im = torch.sin(-2.0 * torch.pi * nd / D).to(float)
        return {
            "x": _w((lambda *s: torch.randn(*s, dtype=torch.bfloat16) * 0.05)(B, S, D)),
            "dft_seq_re": _w(Ws_re),
            "dft_seq_im": _w(Ws_im),
            "dft_hid_re": _w(Wd_re),
            "dft_hid_im": _w(Wd_im),
        }
    _A_in = _A_setup()

    def _B_setup():
        B, S, D, F = 1, 2048, 512, 1792
        return {
            "x": _w((lambda *s: torch.randn(*s, dtype=torch.bfloat16) * 0.05)(B, S, D)),
            "w_gate": _w((lambda *s: torch.randn(*s, dtype=torch.bfloat16) * 1.6)(D, F)),
            "w_up": _w((lambda *s: torch.randn(*s, dtype=torch.bfloat16) * 0.8)(D, F)),
            "w_down": _w((lambda *s: torch.randn(*s, dtype=torch.bfloat16) * 0.8)(F, D)),
        }
    _B_in = _B_setup()

    return {
        "A_x": _A_in["x"],
        "A_dft_seq_re": _A_in["dft_seq_re"],
        "A_dft_seq_im": _A_in["dft_seq_im"],
        "A_dft_hid_re": _A_in["dft_hid_re"],
        "A_dft_hid_im": _A_in["dft_hid_im"],
        "B_x": _B_in["x"],
        "B_w_gate": _B_in["w_gate"],
        "B_w_up": _B_in["w_up"],
        "B_w_down": _B_in["w_down"],
        "gate_w": _w((lambda *s: torch.randn(*s, dtype=torch.bfloat16) * 0.05)(512) * 16.0),
    }

def reference(A_x, A_dft_seq_re, A_dft_seq_im, A_dft_hid_re, A_dft_hid_im, B_x, B_w_gate, B_w_up, B_w_down, gate_w):
    def _A_ref(x, dft_seq_re, dft_seq_im, dft_hid_re, dft_hid_im):
        a = torch.einsum("bsd,ed->bse", x, dft_hid_re)
        b = torch.einsum("bsd,ed->bse", x, dft_hid_im)
        y = torch.einsum("ts,bse->bte", dft_seq_re, a) - torch.einsum("ts,bse->bte", dft_seq_im, b)
        return y

    def _B_ref(x, w_gate, w_up, w_down):
        g = torch.einsum("bsd,df->bsf", x, w_gate)
        u = torch.einsum("bsd,df->bsf", x, w_up)
        h = _sigmoid(g) * u
        return torch.einsum("bsf,fd->bsd", h, w_down)

    x = A_x
    g = _sigmoid((x * gate_w).sum(-1, keepdims=True))
    a = _A_ref(x, A_dft_seq_re, A_dft_seq_im, A_dft_hid_re, A_dft_hid_im)
    b = _B_ref(x, B_w_gate, B_w_up, B_w_down)
    return g * a + (1 - g) * b
```

```asm
; @launch kernel=k1_kernel grid=(256,1,1) block=(512,1,1) lds=160768
; @launch kernel=k2_kernel grid=(256,1,1) block=(512,1,1) lds=163840
.amdgcn_target "amdgcn-amd-amdhsa--gfx950"
.text
.globl k1_kernel
.p2align 8
.type k1_kernel,@function
k1_kernel:
    s_cmp_ge_u32 s2, 256
    s_cbranch_scc1 K1_END
    s_load_dwordx16 s[64:79], s[0:1], 0
    s_load_dwordx4 s[80:83], s[0:1], 64
    s_load_dwordx2 s[88:89], s[0:1], 96
    v_lshrrev_b32 v1, 6, v0
    v_and_b32 v2, 63, v0
    s_and_b32 s4, s2, 7
    v_readfirstlane_b32 s87, v1
    s_lshr_b32 s5, s2, 3
    s_lshr_b32 s6, s4, 1
    s_lshl_b32 s6, s6, 2
    s_and_b32 s7, s5, 3
    s_add_u32 s96, s6, s7
    s_and_b32 s6, s4, 1
    s_lshl_b32 s6, s6, 3
    s_lshr_b32 s7, s5, 2
    s_add_u32 s97, s6, s7
    s_and_b32 s3, s87, 3
    s_and_b32 s6, s97, 3
    s_lshr_b32 s7, s97, 2
    s_cmp_eq_u32 s6, 3
    s_cselect_b32 s100, 1, 0
    s_sub_u32 s86, s97, s7
    s_lshl_b32 s98, s86, 7
    s_mov_b32 s99, s86
    s_lshl_b32 s86, s7, 6
    s_add_u32 s86, s86, 1536
    s_mul_i32 s6, s7, 5
    s_add_u32 s6, s6, 12
    s_cmp_eq_u32 s100, 1
    s_cselect_b32 s98, s86, s98
    s_cselect_b32 s99, s6, s99
    s_and_b32 s6, s96, 3
    s_lshl_b32 s6, s6, 1
    s_add_u32 s6, s6, s97
    s_and_b32 s95, s6, 7
    s_mov_b32 s95, 0
    s_cmp_ge_u32 s87, 4
    s_cbranch_scc0 K1_COMP
    s_lshl_b32 s86, s96, 7
    v_lshrrev_b32 v240, 3, v2
    s_mul_i32 s6, s3, 32
    s_add_u32 s6, s6, s86
    v_add_u32 v240, s6, v240
    s_mov_b32 s7, 1024
    v_mul_lo_u32 v240, v240, s7
    v_lshrrev_b32 v241, 4, v2
    v_and_b32 v242, 7, v2
    v_add_u32 v243, 0, v241
    v_and_b32 v243, 7, v243
    v_xor_b32 v243, v243, v242
    v_lshlrev_b32 v243, 4, v243
    v_add_u32 v243, v243, v240
    v_add_u32 v4, 0x0, v243
    v_add_u32 v243, 4, v241
    v_and_b32 v243, 7, v243
    v_xor_b32 v243, v243, v242
    v_lshlrev_b32 v243, 4, v243
    v_add_u32 v243, v243, v240
    v_add_u32 v5, 0x1c00, v243
    v_add_u32 v243, 8, v241
    v_and_b32 v243, 7, v243
    v_xor_b32 v243, v243, v242
    v_lshlrev_b32 v243, 4, v243
    v_add_u32 v243, v243, v240
    v_add_u32 v6, 0x3800, v243
    v_add_u32 v243, 12, v241
    v_and_b32 v243, 7, v243
    v_xor_b32 v243, v243, v242
    v_lshlrev_b32 v243, 4, v243
    v_add_u32 v243, v243, v240
    v_add_u32 v7, 0x5400, v243
    v_lshrrev_b32 v240, 3, v2
    s_lshl_b32 s6, s3, 3
    v_add_u32 v240, s6, v240
    v_lshrrev_b32 v241, 1, v240
    v_and_b32 v241, 7, v241
    v_and_b32 v242, 7, v2
    v_xor_b32 v241, v241, v242
    v_lshlrev_b32 v241, 4, v241
    v_lshlrev_b32 v240, 10, v240
    v_add_u32 v12, v240, v241
    s_lshl_b32 s85, s3, 10
    s_waitcnt lgkmcnt(0)
    s_mov_b32 s8, s64
    s_mov_b32 s9, s65
    s_and_b32 s9, s9, 0xffff
    s_mov_b32 s10, 0x200000
    s_mov_b32 s11, 0x00020000
    s_mov_b32 s12, s76
    s_mov_b32 s13, s77
    s_and_b32 s13, s13, 0xffff
    s_mov_b32 s14, 0x1c0000
    s_mov_b32 s15, 0x00020000
    s_mov_b32 s16, s78
    s_mov_b32 s17, s79
    s_and_b32 s17, s17, 0xffff
    s_mov_b32 s18, 0x1c0000
    s_mov_b32 s19, 0x00020000
    s_mov_b32 s36, s82
    s_mov_b32 s37, s83
    s_and_b32 s37, s37, 0xffff
    s_mov_b32 s38, 0x400
    s_mov_b32 s39, 0x00020000
    s_mov_b32 s93, s97
    s_mov_b32 s94, s96
    s_add_u32 s6, s99, 0
    s_cmp_lt_u32 s6, 16
    s_cselect_b32 s7, s70, s72
    s_cselect_b32 s86, s71, s73
    s_and_b32 s6, s6, 15
    s_lshl_b32 s6, s6, 15
    s_add_u32 s44, s7, s6
    s_addc_u32 s45, s86, 0
    s_and_b32 s45, s45, 0xffff
    s_mov_b32 s46, 32768
    s_mov_b32 s47, 0x00020000
    s_add_u32 s6, s99, 1
    s_cmp_lt_u32 s6, 16
    s_cselect_b32 s7, s70, s72
    s_cselect_b32 s86, s71, s73
    s_and_b32 s6, s6, 15
    s_lshl_b32 s6, s6, 15
    s_add_u32 s48, s7, s6
    s_addc_u32 s49, s86, 0
    s_and_b32 s49, s49, 0xffff
    s_mov_b32 s50, 32768
    s_mov_b32 s51, 0x00020000
    s_add_u32 s6, s99, 2
    s_cmp_lt_u32 s6, 16
    s_cselect_b32 s7, s70, s72
    s_cselect_b32 s86, s71, s73
    s_and_b32 s6, s6, 15
    s_lshl_b32 s6, s6, 15
    s_add_u32 s52, s7, s6
    s_addc_u32 s53, s86, 0
    s_and_b32 s53, s53, 0xffff
    s_mov_b32 s54, 32768
    s_mov_b32 s55, 0x00020000
    s_add_u32 s6, s99, 3
    s_cmp_lt_u32 s6, 16
    s_cselect_b32 s7, s70, s72
    s_cselect_b32 s86, s71, s73
    s_and_b32 s6, s6, 15
    s_lshl_b32 s6, s6, 15
    s_add_u32 s56, s7, s6
    s_addc_u32 s57, s86, 0
    s_and_b32 s57, s57, 0xffff
    s_mov_b32 s58, 32768
    s_mov_b32 s59, 0x00020000
    s_add_u32 s6, s99, 4
    s_cmp_lt_u32 s6, 16
    s_cselect_b32 s7, s70, s72
    s_cselect_b32 s86, s71, s73
    s_and_b32 s6, s6, 15
    s_lshl_b32 s6, s6, 15
    s_add_u32 s60, s7, s6
    s_addc_u32 s61, s86, 0
    s_and_b32 s61, s61, 0xffff
    s_mov_b32 s62, 32768
    s_mov_b32 s63, 0x00020000
    s_cmp_eq_u32 s100, 1
    s_cbranch_scc1 K1_LC
    v_lshrrev_b32 v240, 4, v2
    v_lshlrev_b32 v241, 2, v240
    v_and_b32 v242, 15, v2
    v_xor_b32 v241, v241, v242
    s_lshl_b32 s6, s3, 4
    v_add_u32 v240, s6, v240
    s_movk_i32 s7, 3584
    v_mul_lo_u32 v240, v240, s7
    s_lshl_b32 s6, s98, 1
    v_add_u32 v240, s6, v240
    v_xor_b32 v242, 0, v241
    v_lshl_add_u32 v242, v242, 4, v240
    v_add_u32 v8, 0x0, v242
    v_xor_b32 v242, 0, v241
    v_lshl_add_u32 v242, v242, 4, v240
    v_add_u32 v9, 0x3400, v242
    v_xor_b32 v242, 2, v241
    v_lshl_add_u32 v242, v242, 4, v240
    v_add_u32 v10, 0x6800, v242
    v_xor_b32 v242, 2, v241
    v_lshl_add_u32 v242, v242, 4, v240
    v_add_u32 v11, 0x9c00, v242
    s_lshl_b32 s86, s3, 12
    s_mul_i32 s84, s3, 4096
    s_add_u32 m0, s84, 0x4000
    s_add_u32 s7, s95, 0
    s_and_b32 s7, s7, 7
    s_mul_i32 s101, s7, 0x38000
    buffer_load_dwordx4 v8, s[12:15], s101 offen offset:0 lds
    buffer_load_dwordx4 v9, s[12:15], s101 offen offset:1024 lds
    buffer_load_dwordx4 v10, s[12:15], s101 offen offset:2048 lds
    buffer_load_dwordx4 v11, s[12:15], s101 offen offset:3072 lds
    s_add_u32 m0, s84, 0x8000
    s_nop 0
    buffer_load_dwordx4 v8, s[16:19], s101 offen offset:0 lds
    buffer_load_dwordx4 v9, s[16:19], s101 offen offset:1024 lds
    buffer_load_dwordx4 v10, s[16:19], s101 offen offset:2048 lds
    buffer_load_dwordx4 v11, s[16:19], s101 offen offset:3072 lds
    s_add_u32 m0, s86, 0x0
    s_lshl_b32 s101, s7, 7
    buffer_load_dwordx4 v4, s[8:11], s101 offen offset:0 lds
    buffer_load_dwordx4 v5, s[8:11], s101 offen offset:1024 lds
    buffer_load_dwordx4 v6, s[8:11], s101 offen offset:2048 lds
    buffer_load_dwordx4 v7, s[8:11], s101 offen offset:3072 lds
    s_add_u32 m0, s85, 0xc000
    s_nop 0
    buffer_load_dwordx4 v12, s[44:47], s101 offen lds
    s_add_u32 m0, s84, 0x11000
    s_add_u32 s7, s95, 1
    s_and_b32 s7, s7, 7
    s_mul_i32 s101, s7, 0x38000
    buffer_load_dwordx4 v8, s[12:15], s101 offen offset:0 lds
    buffer_load_dwordx4 v9, s[12:15], s101 offen offset:1024 lds
    buffer_load_dwordx4 v10, s[12:15], s101 offen offset:2048 lds
    buffer_load_dwordx4 v11, s[12:15], s101 offen offset:3072 lds
    s_add_u32 m0, s84, 0x15000
    s_nop 0
    buffer_load_dwordx4 v8, s[16:19], s101 offen offset:0 lds
    buffer_load_dwordx4 v9, s[16:19], s101 offen offset:1024 lds
    buffer_load_dwordx4 v10, s[16:19], s101 offen offset:2048 lds
    buffer_load_dwordx4 v11, s[16:19], s101 offen offset:3072 lds
    s_add_u32 m0, s86, 0xd000
    s_lshl_b32 s101, s7, 7
    buffer_load_dwordx4 v4, s[8:11], s101 offen offset:0 lds
    buffer_load_dwordx4 v5, s[8:11], s101 offen offset:1024 lds
    buffer_load_dwordx4 v6, s[8:11], s101 offen offset:2048 lds
    buffer_load_dwordx4 v7, s[8:11], s101 offen offset:3072 lds
    s_add_u32 m0, s85, 0x19000
    s_nop 0
    buffer_load_dwordx4 v12, s[44:47], s101 offen lds
    s_waitcnt vmcnt(13)
    s_barrier
    s_add_u32 m0, s84, 0x1e000
    s_add_u32 s7, s95, 2
    s_and_b32 s7, s7, 7
    s_mul_i32 s101, s7, 0x38000
    buffer_load_dwordx4 v8, s[12:15], s101 offen offset:0 lds
    buffer_load_dwordx4 v9, s[12:15], s101 offen offset:1024 lds
    buffer_load_dwordx4 v10, s[12:15], s101 offen offset:2048 lds
    buffer_load_dwordx4 v11, s[12:15], s101 offen offset:3072 lds
    s_add_u32 m0, s84, 0x22000
    s_nop 0
    buffer_load_dwordx4 v8, s[16:19], s101 offen offset:0 lds
    buffer_load_dwordx4 v9, s[16:19], s101 offen offset:1024 lds
    buffer_load_dwordx4 v10, s[16:19], s101 offen offset:2048 lds
    buffer_load_dwordx4 v11, s[16:19], s101 offen offset:3072 lds
    s_add_u32 m0, s86, 0x1a000
    s_lshl_b32 s101, s7, 7
    buffer_load_dwordx4 v4, s[8:11], s101 offen offset:0 lds
    buffer_load_dwordx4 v5, s[8:11], s101 offen offset:1024 lds
    buffer_load_dwordx4 v6, s[8:11], s101 offen offset:2048 lds
    buffer_load_dwordx4 v7, s[8:11], s101 offen offset:3072 lds
    s_add_u32 m0, s85, 0x26000
    s_nop 0
    buffer_load_dwordx4 v12, s[44:47], s101 offen lds
    s_waitcnt vmcnt(13)
    s_barrier
    s_add_u32 m0, s84, 0x4000
    s_add_u32 s7, s95, 3
    s_and_b32 s7, s7, 7
    s_mul_i32 s101, s7, 0x38000
    buffer_load_dwordx4 v8, s[12:15], s101 offen offset:0 lds
    buffer_load_dwordx4 v9, s[12:15], s101 offen offset:1024 lds
    buffer_load_dwordx4 v10, s[12:15], s101 offen offset:2048 lds
    buffer_load_dwordx4 v11, s[12:15], s101 offen offset:3072 lds
    s_add_u32 m0, s84, 0x8000
    s_nop 0
    buffer_load_dwordx4 v8, s[16:19], s101 offen offset:0 lds
    buffer_load_dwordx4 v9, s[16:19], s101 offen offset:1024 lds
    buffer_load_dwordx4 v10, s[16:19], s101 offen offset:2048 lds
    buffer_load_dwordx4 v11, s[16:19], s101 offen offset:3072 lds
    s_add_u32 m0, s86, 0x0
    s_lshl_b32 s101, s7, 7
    buffer_load_dwordx4 v4, s[8:11], s101 offen offset:0 lds
    buffer_load_dwordx4 v5, s[8:11], s101 offen offset:1024 lds
    buffer_load_dwordx4 v6, s[8:11], s101 offen offset:2048 lds
    buffer_load_dwordx4 v7, s[8:11], s101 offen offset:3072 lds
    s_add_u32 m0, s85, 0xc000
    s_nop 0
    buffer_load_dwordx4 v12, s[44:47], s101 offen lds
    s_waitcnt vmcnt(13)
    s_barrier
    s_add_u32 m0, s84, 0x11000
    s_add_u32 s7, s95, 4
    s_and_b32 s7, s7, 7
    s_mul_i32 s101, s7, 0x38000
    buffer_load_dwordx4 v8, s[12:15], s101 offen offset:0 lds
    buffer_load_dwordx4 v9, s[12:15], s101 offen offset:1024 lds
    buffer_load_dwordx4 v10, s[12:15], s101 offen offset:2048 lds
    buffer_load_dwordx4 v11, s[12:15], s101 offen offset:3072 lds
    s_add_u32 m0, s84, 0x15000
    s_nop 0
    buffer_load_dwordx4 v8, s[16:19], s101 offen offset:0 lds
    buffer_load_dwordx4 v9, s[16:19], s101 offen offset:1024 lds
    buffer_load_dwordx4 v10, s[16:19], s101 offen offset:2048 lds
    buffer_load_dwordx4 v11, s[16:19], s101 offen offset:3072 lds
    s_add_u32 m0, s86, 0xd000
    s_lshl_b32 s101, s7, 7
    buffer_load_dwordx4 v4, s[8:11], s101 offen offset:0 lds
    buffer_load_dwordx4 v5, s[8:11], s101 offen offset:1024 lds
    buffer_load_dwordx4 v6, s[8:11], s101 offen offset:2048 lds
    buffer_load_dwordx4 v7, s[8:11], s101 offen offset:3072 lds
    s_add_u32 m0, s85, 0x19000
    s_nop 0
    buffer_load_dwordx4 v12, s[44:47], s101 offen lds
    s_waitcnt vmcnt(13)
    s_barrier
    s_add_u32 m0, s84, 0x1e000
    s_add_u32 s7, s95, 5
    s_and_b32 s7, s7, 7
    s_mul_i32 s101, s7, 0x38000
    buffer_load_dwordx4 v8, s[12:15], s101 offen offset:0 lds
    buffer_load_dwordx4 v9, s[12:15], s101 offen offset:1024 lds
    buffer_load_dwordx4 v10, s[12:15], s101 offen offset:2048 lds
    buffer_load_dwordx4 v11, s[12:15], s101 offen offset:3072 lds
    s_add_u32 m0, s84, 0x22000
    s_nop 0
    buffer_load_dwordx4 v8, s[16:19], s101 offen offset:0 lds
    buffer_load_dwordx4 v9, s[16:19], s101 offen offset:1024 lds
    buffer_load_dwordx4 v10, s[16:19], s101 offen offset:2048 lds
    buffer_load_dwordx4 v11, s[16:19], s101 offen offset:3072 lds
    s_add_u32 m0, s86, 0x1a000
    s_lshl_b32 s101, s7, 7
    buffer_load_dwordx4 v4, s[8:11], s101 offen offset:0 lds
    buffer_load_dwordx4 v5, s[8:11], s101 offen offset:1024 lds
    buffer_load_dwordx4 v6, s[8:11], s101 offen offset:2048 lds
    buffer_load_dwordx4 v7, s[8:11], s101 offen offset:3072 lds
    s_add_u32 m0, s85, 0x26000
    s_nop 0
    buffer_load_dwordx4 v12, s[44:47], s101 offen lds
    s_waitcnt vmcnt(13)
    s_barrier
    s_add_u32 m0, s84, 0x4000
    s_add_u32 s7, s95, 6
    s_and_b32 s7, s7, 7
    s_mul_i32 s101, s7, 0x38000
    buffer_load_dwordx4 v8, s[12:15], s101 offen offset:0 lds
    buffer_load_dwordx4 v9, s[12:15], s101 offen offset:1024 lds
    buffer_load_dwordx4 v10, s[12:15], s101 offen offset:2048 lds
    buffer_load_dwordx4 v11, s[12:15], s101 offen offset:3072 lds
    s_add_u32 m0, s84, 0x8000
    s_nop 0
    buffer_load_dwordx4 v8, s[16:19], s101 offen offset:0 lds
    buffer_load_dwordx4 v9, s[16:19], s101 offen offset:1024 lds
    buffer_load_dwordx4 v10, s[16:19], s101 offen offset:2048 lds
    buffer_load_dwordx4 v11, s[16:19], s101 offen offset:3072 lds
    s_add_u32 m0, s86, 0x0
    s_lshl_b32 s101, s7, 7
    buffer_load_dwordx4 v4, s[8:11], s101 offen offset:0 lds
    buffer_load_dwordx4 v5, s[8:11], s101 offen offset:1024 lds
    buffer_load_dwordx4 v6, s[8:11], s101 offen offset:2048 lds
    buffer_load_dwordx4 v7, s[8:11], s101 offen offset:3072 lds
    s_add_u32 m0, s85, 0xc000
    s_nop 0
    buffer_load_dwordx4 v12, s[44:47], s101 offen lds
    s_waitcnt vmcnt(13)
    s_barrier
    s_add_u32 m0, s84, 0x11000
    s_add_u32 s7, s95, 7
    s_and_b32 s7, s7, 7
    s_mul_i32 s101, s7, 0x38000
    buffer_load_dwordx4 v8, s[12:15], s101 offen offset:0 lds
    buffer_load_dwordx4 v9, s[12:15], s101 offen offset:1024 lds
    buffer_load_dwordx4 v10, s[12:15], s101 offen offset:2048 lds
    buffer_load_dwordx4 v11, s[12:15], s101 offen offset:3072 lds
    s_add_u32 m0, s84, 0x15000
    s_nop 0
    buffer_load_dwordx4 v8, s[16:19], s101 offen offset:0 lds
    buffer_load_dwordx4 v9, s[16:19], s101 offen offset:1024 lds
    buffer_load_dwordx4 v10, s[16:19], s101 offen offset:2048 lds
    buffer_load_dwordx4 v11, s[16:19], s101 offen offset:3072 lds
    s_add_u32 m0, s86, 0xd000
    s_lshl_b32 s101, s7, 7
    buffer_load_dwordx4 v4, s[8:11], s101 offen offset:0 lds
    buffer_load_dwordx4 v5, s[8:11], s101 offen offset:1024 lds
    buffer_load_dwordx4 v6, s[8:11], s101 offen offset:2048 lds
    buffer_load_dwordx4 v7, s[8:11], s101 offen offset:3072 lds
    s_add_u32 m0, s85, 0x19000
    s_nop 0
    buffer_load_dwordx4 v12, s[44:47], s101 offen lds
    s_waitcnt vmcnt(13)
    s_barrier
    s_branch K1_LTAIL
K1_LC:
    v_lshrrev_b32 v240, 3, v2
    v_bfe_u32 v241, v2, 4, 1
    v_lshlrev_b32 v241, 1, v241
    v_and_b32 v242, 7, v2
    v_xor_b32 v241, v241, v242
    s_lshl_b32 s6, s3, 4
    v_add_u32 v240, s6, v240
    s_movk_i32 s7, 3584
    v_mul_lo_u32 v240, v240, s7
    s_lshl_b32 s6, s98, 1
    v_add_u32 v240, s6, v240
    v_xor_b32 v242, 0, v241
    v_lshl_add_u32 v242, v242, 4, v240
    v_add_u32 v8, 0x0, v242
    v_xor_b32 v242, 4, v241
    v_lshl_add_u32 v242, v242, 4, v240
    v_add_u32 v9, 0x6c00, v242
    s_lshl_b32 s86, s3, 12
    s_mul_i32 s84, s3, 2048
    s_add_u32 m0, s84, 0x4000
    s_add_u32 s7, s95, 0
    s_and_b32 s7, s7, 7
    s_mul_i32 s101, s7, 0x38000
    buffer_load_dwordx4 v8, s[12:15], s101 offen offset:0 lds
    buffer_load_dwordx4 v9, s[12:15], s101 offen offset:1024 lds
    s_add_u32 m0, s84, 0x6000
    s_nop 0
    buffer_load_dwordx4 v8, s[16:19], s101 offen offset:0 lds
    buffer_load_dwordx4 v9, s[16:19], s101 offen offset:1024 lds
    s_add_u32 m0, s86, 0x0
    s_lshl_b32 s101, s7, 7
    buffer_load_dwordx4 v4, s[8:11], s101 offen offset:0 lds
    buffer_load_dwordx4 v5, s[8:11], s101 offen offset:1024 lds
    buffer_load_dwordx4 v6, s[8:11], s101 offen offset:2048 lds
    buffer_load_dwordx4 v7, s[8:11], s101 offen offset:3072 lds
    s_add_u32 m0, s85, 0x8000
    s_nop 0
    buffer_load_dwordx4 v12, s[44:47], s101 offen lds
    s_add_u32 m0, s85, 0x9000
    s_nop 0
    buffer_load_dwordx4 v12, s[48:51], s101 offen lds
    s_add_u32 m0, s85, 0xa000
    s_nop 0
    buffer_load_dwordx4 v12, s[52:55], s101 offen lds
    s_add_u32 m0, s85, 0xb000
    s_nop 0
    buffer_load_dwordx4 v12, s[56:59], s101 offen lds
    s_add_u32 m0, s85, 0xc000
    s_nop 0
    buffer_load_dwordx4 v12, s[60:63], s101 offen lds
    s_add_u32 m0, s84, 0x11000
    s_add_u32 s7, s95, 1
    s_and_b32 s7, s7, 7
    s_mul_i32 s101, s7, 0x38000
    buffer_load_dwordx4 v8, s[12:15], s101 offen offset:0 lds
    buffer_load_dwordx4 v9, s[12:15], s101 offen offset:1024 lds
    s_add_u32 m0, s84, 0x13000
    s_nop 0
    buffer_load_dwordx4 v8, s[16:19], s101 offen offset:0 lds
    buffer_load_dwordx4 v9, s[16:19], s101 offen offset:1024 lds
    s_add_u32 m0, s86, 0xd000
    s_lshl_b32 s101, s7, 7
    buffer_load_dwordx4 v4, s[8:11], s101 offen offset:0 lds
    buffer_load_dwordx4 v5, s[8:11], s101 offen offset:1024 lds
    buffer_load_dwordx4 v6, s[8:11], s101 offen offset:2048 lds
    buffer_load_dwordx4 v7, s[8:11], s101 offen offset:3072 lds
    s_add_u32 m0, s85, 0x15000
    s_nop 0
    buffer_load_dwordx4 v12, s[44:47], s101 offen lds
    s_add_u32 m0, s85, 0x16000
    s_nop 0
    buffer_load_dwordx4 v12, s[48:51], s101 offen lds
    s_add_u32 m0, s85, 0x17000
    s_nop 0
    buffer_load_dwordx4 v12, s[52:55], s101 offen lds
    s_add_u32 m0, s85, 0x18000
    s_nop 0
    buffer_load_dwordx4 v12, s[56:59], s101 offen lds
    s_add_u32 m0, s85, 0x19000
    s_nop 0
    buffer_load_dwordx4 v12, s[60:63], s101 offen lds
    s_waitcnt vmcnt(13)
    s_barrier
    s_add_u32 m0, s84, 0x1e000
    s_add_u32 s7, s95, 2
    s_and_b32 s7, s7, 7
    s_mul_i32 s101, s7, 0x38000
    buffer_load_dwordx4 v8, s[12:15], s101 offen offset:0 lds
    buffer_load_dwordx4 v9, s[12:15], s101 offen offset:1024 lds
    s_add_u32 m0, s84, 0x20000
    s_nop 0
    buffer_load_dwordx4 v8, s[16:19], s101 offen offset:0 lds
    buffer_load_dwordx4 v9, s[16:19], s101 offen offset:1024 lds
    s_add_u32 m0, s86, 0x1a000
    s_lshl_b32 s101, s7, 7
    buffer_load_dwordx4 v4, s[8:11], s101 offen offset:0 lds
    buffer_load_dwordx4 v5, s[8:11], s101 offen offset:1024 lds
    buffer_load_dwordx4 v6, s[8:11], s101 offen offset:2048 lds
    buffer_load_dwordx4 v7, s[8:11], s101 offen offset:3072 lds
    s_add_u32 m0, s85, 0x22000
    s_nop 0
    buffer_load_dwordx4 v12, s[44:47], s101 offen lds
    s_add_u32 m0, s85, 0x23000
    s_nop 0
    buffer_load_dwordx4 v12, s[48:51], s101 offen lds
    s_add_u32 m0, s85, 0x24000
    s_nop 0
    buffer_load_dwordx4 v12, s[52:55], s101 offen lds
    s_add_u32 m0, s85, 0x25000
    s_nop 0
    buffer_load_dwordx4 v12, s[56:59], s101 offen lds
    s_add_u32 m0, s85, 0x26000
    s_nop 0
    buffer_load_dwordx4 v12, s[60:63], s101 offen lds
    s_waitcnt vmcnt(13)
    s_barrier
    s_add_u32 m0, s84, 0x4000
    s_add_u32 s7, s95, 3
    s_and_b32 s7, s7, 7
    s_mul_i32 s101, s7, 0x38000
    buffer_load_dwordx4 v8, s[12:15], s101 offen offset:0 lds
    buffer_load_dwordx4 v9, s[12:15], s101 offen offset:1024 lds
    s_add_u32 m0, s84, 0x6000
    s_nop 0
    buffer_load_dwordx4 v8, s[16:19], s101 offen offset:0 lds
    buffer_load_dwordx4 v9, s[16:19], s101 offen offset:1024 lds
    s_add_u32 m0, s86, 0x0
    s_lshl_b32 s101, s7, 7
    buffer_load_dwordx4 v4, s[8:11], s101 offen offset:0 lds
    buffer_load_dwordx4 v5, s[8:11], s101 offen offset:1024 lds
    buffer_load_dwordx4 v6, s[8:11], s101 offen offset:2048 lds
    buffer_load_dwordx4 v7, s[8:11], s101 offen offset:3072 lds
    s_add_u32 m0, s85, 0x8000
    s_nop 0
    buffer_load_dwordx4 v12, s[44:47], s101 offen lds
    s_add_u32 m0, s85, 0x9000
    s_nop 0
    buffer_load_dwordx4 v12, s[48:51], s101 offen lds
    s_add_u32 m0, s85, 0xa000
    s_nop 0
    buffer_load_dwordx4 v12, s[52:55], s101 offen lds
    s_add_u32 m0, s85, 0xb000
    s_nop 0
    buffer_load_dwordx4 v12, s[56:59], s101 offen lds
    s_add_u32 m0, s85, 0xc000
    s_nop 0
    buffer_load_dwordx4 v12, s[60:63], s101 offen lds
    s_waitcnt vmcnt(13)
    s_barrier
    s_add_u32 m0, s84, 0x11000
    s_add_u32 s7, s95, 4
    s_and_b32 s7, s7, 7
    s_mul_i32 s101, s7, 0x38000
    buffer_load_dwordx4 v8, s[12:15], s101 offen offset:0 lds
    buffer_load_dwordx4 v9, s[12:15], s101 offen offset:1024 lds
    s_add_u32 m0, s84, 0x13000
    s_nop 0
    buffer_load_dwordx4 v8, s[16:19], s101 offen offset:0 lds
    buffer_load_dwordx4 v9, s[16:19], s101 offen offset:1024 lds
    s_add_u32 m0, s86, 0xd000
    s_lshl_b32 s101, s7, 7
    buffer_load_dwordx4 v4, s[8:11], s101 offen offset:0 lds
    buffer_load_dwordx4 v5, s[8:11], s101 offen offset:1024 lds
    buffer_load_dwordx4 v6, s[8:11], s101 offen offset:2048 lds
    buffer_load_dwordx4 v7, s[8:11], s101 offen offset:3072 lds
    s_add_u32 m0, s85, 0x15000
    s_nop 0
    buffer_load_dwordx4 v12, s[44:47], s101 offen lds
    s_add_u32 m0, s85, 0x16000
    s_nop 0
    buffer_load_dwordx4 v12, s[48:51], s101 offen lds
    s_add_u32 m0, s85, 0x17000
    s_nop 0
    buffer_load_dwordx4 v12, s[52:55], s101 offen lds
    s_add_u32 m0, s85, 0x18000
    s_nop 0
    buffer_load_dwordx4 v12, s[56:59], s101 offen lds
    s_add_u32 m0, s85, 0x19000
    s_nop 0
    buffer_load_dwordx4 v12, s[60:63], s101 offen lds
    s_waitcnt vmcnt(13)
    s_barrier
    s_add_u32 m0, s84, 0x1e000
    s_add_u32 s7, s95, 5
    s_and_b32 s7, s7, 7
    s_mul_i32 s101, s7, 0x38000
    buffer_load_dwordx4 v8, s[12:15], s101 offen offset:0 lds
    buffer_load_dwordx4 v9, s[12:15], s101 offen offset:1024 lds
    s_add_u32 m0, s84, 0x20000
    s_nop 0
    buffer_load_dwordx4 v8, s[16:19], s101 offen offset:0 lds
    buffer_load_dwordx4 v9, s[16:19], s101 offen offset:1024 lds
    s_add_u32 m0, s86, 0x1a000
    s_lshl_b32 s101, s7, 7
    buffer_load_dwordx4 v4, s[8:11], s101 offen offset:0 lds
    buffer_load_dwordx4 v5, s[8:11], s101 offen offset:1024 lds
    buffer_load_dwordx4 v6, s[8:11], s101 offen offset:2048 lds
    buffer_load_dwordx4 v7, s[8:11], s101 offen offset:3072 lds
    s_add_u32 m0, s85, 0x22000
    s_nop 0
    buffer_load_dwordx4 v12, s[44:47], s101 offen lds
    s_add_u32 m0, s85, 0x23000
    s_nop 0
    buffer_load_dwordx4 v12, s[48:51], s101 offen lds
    s_add_u32 m0, s85, 0x24000
    s_nop 0
    buffer_load_dwordx4 v12, s[52:55], s101 offen lds
    s_add_u32 m0, s85, 0x25000
    s_nop 0
    buffer_load_dwordx4 v12, s[56:59], s101 offen lds
    s_add_u32 m0, s85, 0x26000
    s_nop 0
    buffer_load_dwordx4 v12, s[60:63], s101 offen lds
    s_waitcnt vmcnt(13)
    s_barrier
    s_add_u32 m0, s84, 0x4000
    s_add_u32 s7, s95, 6
    s_and_b32 s7, s7, 7
    s_mul_i32 s101, s7, 0x38000
    buffer_load_dwordx4 v8, s[12:15], s101 offen offset:0 lds
    buffer_load_dwordx4 v9, s[12:15], s101 offen offset:1024 lds
    s_add_u32 m0, s84, 0x6000
    s_nop 0
    buffer_load_dwordx4 v8, s[16:19], s101 offen offset:0 lds
    buffer_load_dwordx4 v9, s[16:19], s101 offen offset:1024 lds
    s_add_u32 m0, s86, 0x0
    s_lshl_b32 s101, s7, 7
    buffer_load_dwordx4 v4, s[8:11], s101 offen offset:0 lds
    buffer_load_dwordx4 v5, s[8:11], s101 offen offset:1024 lds
    buffer_load_dwordx4 v6, s[8:11], s101 offen offset:2048 lds
    buffer_load_dwordx4 v7, s[8:11], s101 offen offset:3072 lds
    s_add_u32 m0, s85, 0x8000
    s_nop 0
    buffer_load_dwordx4 v12, s[44:47], s101 offen lds
    s_add_u32 m0, s85, 0x9000
    s_nop 0
    buffer_load_dwordx4 v12, s[48:51], s101 offen lds
    s_add_u32 m0, s85, 0xa000
    s_nop 0
    buffer_load_dwordx4 v12, s[52:55], s101 offen lds
    s_add_u32 m0, s85, 0xb000
    s_nop 0
    buffer_load_dwordx4 v12, s[56:59], s101 offen lds
    s_add_u32 m0, s85, 0xc000
    s_nop 0
    buffer_load_dwordx4 v12, s[60:63], s101 offen lds
    s_waitcnt vmcnt(13)
    s_barrier
    s_add_u32 m0, s84, 0x11000
    s_add_u32 s7, s95, 7
    s_and_b32 s7, s7, 7
    s_mul_i32 s101, s7, 0x38000
    buffer_load_dwordx4 v8, s[12:15], s101 offen offset:0 lds
    buffer_load_dwordx4 v9, s[12:15], s101 offen offset:1024 lds
    s_add_u32 m0, s84, 0x13000
    s_nop 0
    buffer_load_dwordx4 v8, s[16:19], s101 offen offset:0 lds
    buffer_load_dwordx4 v9, s[16:19], s101 offen offset:1024 lds
    s_add_u32 m0, s86, 0xd000
    s_lshl_b32 s101, s7, 7
    buffer_load_dwordx4 v4, s[8:11], s101 offen offset:0 lds
    buffer_load_dwordx4 v5, s[8:11], s101 offen offset:1024 lds
    buffer_load_dwordx4 v6, s[8:11], s101 offen offset:2048 lds
    buffer_load_dwordx4 v7, s[8:11], s101 offen offset:3072 lds
    s_add_u32 m0, s85, 0x15000
    s_nop 0
    buffer_load_dwordx4 v12, s[44:47], s101 offen lds
    s_add_u32 m0, s85, 0x16000
    s_nop 0
    buffer_load_dwordx4 v12, s[48:51], s101 offen lds
    s_add_u32 m0, s85, 0x17000
    s_nop 0
    buffer_load_dwordx4 v12, s[52:55], s101 offen lds
    s_add_u32 m0, s85, 0x18000
    s_nop 0
    buffer_load_dwordx4 v12, s[56:59], s101 offen lds
    s_add_u32 m0, s85, 0x19000
    s_nop 0
    buffer_load_dwordx4 v12, s[60:63], s101 offen lds
    s_waitcnt vmcnt(13)
    s_barrier
    s_branch K1_LTAIL
K1_LTAIL:
    s_mov_b32 s28, s80
    s_mov_b32 s29, s81
    s_and_b32 s29, s29, 0xffff
    s_mov_b32 s30, 0x1c0000
    s_mov_b32 s31, 0x00020000
    s_mov_b32 s36, s82
    s_mov_b32 s37, s83
    s_and_b32 s37, s37, 0xffff
    s_mov_b32 s38, 0x400
    s_mov_b32 s39, 0x00020000
    s_mov_b32 s24, s88
    s_mov_b32 s25, s89
    s_and_b32 s25, s25, 0xffff
    s_mov_b32 s26, 0x5c0000
    s_mov_b32 s27, 0x00020000
    s_add_u32 s32, s88, 0x1000000
    s_addc_u32 s33, s89, 0
    s_and_b32 s33, s33, 0xffff
    s_mov_b32 s34, 0x2000
    s_mov_b32 s35, 0x00020000
    s_lshl_b32 s6, s2, 2
    s_add_u32 s97, s6, s3
    v_lshrrev_b32 v240, 1, v2
    v_lshlrev_b32 v240, 10, v240
    v_and_b32 v241, 1, v2
    v_lshlrev_b32 v241, 4, v241
    v_add_u32 v8, v240, v241
    v_add_u32 v9, 0x7c00, v8
    s_min_u32 s86, s97, 895
    s_lshr_b32 s6, s86, 5
    s_lshl_b32 s6, s6, 16
    s_and_b32 s7, s86, 31
    s_lshl_b32 s7, s7, 5
    s_add_u32 s101, s6, s7
    s_lshl_b32 s6, s3, 12
    s_add_u32 m0, s6, 0x1a000
    s_nop 0
    buffer_load_dwordx4 v8, s[28:31], s101 offen offset:0 lds
    buffer_load_dwordx4 v9, s[28:31], s101 offen offset:1024 lds
    v_lshlrev_b32 v240, 4, v2
    buffer_load_dwordx4 v[16:19], v240, s[36:39], 0 offen
    s_lshl_b32 s6, s97, 11
    buffer_load_dwordx4 v[20:23], v240, s[8:11], s6 offen
    buffer_load_dwordx4 v[24:27], v240, s[8:11], s6 offen offset:1024
    s_waitcnt vmcnt(5)
    s_barrier
    s_waitcnt vmcnt(0)
    v_lshlrev_b32 v28, 16, v16
    v_and_b32 v29, 0xffff0000, v16
    v_lshlrev_b32 v30, 16, v17
    v_and_b32 v31, 0xffff0000, v17
    v_lshlrev_b32 v32, 16, v18
    v_and_b32 v33, 0xffff0000, v18
    v_lshlrev_b32 v34, 16, v19
    v_and_b32 v35, 0xffff0000, v19
    v_lshlrev_b32 v242, 16, v20
    v_and_b32 v243, 0xffff0000, v20
    v_mul_f32 v44, v242, v28
    v_fmac_f32 v44, v243, v29
    v_lshlrev_b32 v242, 16, v21
    v_and_b32 v243, 0xffff0000, v21
    v_fmac_f32 v44, v242, v30
    v_fmac_f32 v44, v243, v31
    v_lshlrev_b32 v242, 16, v22
    v_and_b32 v243, 0xffff0000, v22
    v_fmac_f32 v44, v242, v32
    v_fmac_f32 v44, v243, v33
    v_lshlrev_b32 v242, 16, v23
    v_and_b32 v243, 0xffff0000, v23
    v_fmac_f32 v44, v242, v34
    v_fmac_f32 v44, v243, v35
    v_lshlrev_b32 v242, 16, v24
    v_and_b32 v243, 0xffff0000, v24
    v_mul_f32 v45, v242, v28
    v_fmac_f32 v45, v243, v29
    v_lshlrev_b32 v242, 16, v25
    v_and_b32 v243, 0xffff0000, v25
    v_fmac_f32 v45, v242, v30
    v_fmac_f32 v45, v243, v31
    v_lshlrev_b32 v242, 16, v26
    v_and_b32 v243, 0xffff0000, v26
    v_fmac_f32 v45, v242, v32
    v_fmac_f32 v45, v243, v33
    v_lshlrev_b32 v242, 16, v27
    v_and_b32 v243, 0xffff0000, v27
    v_fmac_f32 v45, v242, v34
    v_fmac_f32 v45, v243, v35
    ds_swizzle_b32 v46, v44 offset:0x41f
    ds_swizzle_b32 v47, v45 offset:0x41f
    s_waitcnt lgkmcnt(0)
    v_add_f32 v44, v44, v46
    v_add_f32 v45, v45, v47
    ds_swizzle_b32 v46, v44 offset:0x81f
    ds_swizzle_b32 v47, v45 offset:0x81f
    s_waitcnt lgkmcnt(0)
    v_add_f32 v44, v44, v46
    v_add_f32 v45, v45, v47
    ds_swizzle_b32 v46, v44 offset:0x101f
    ds_swizzle_b32 v47, v45 offset:0x101f
    s_waitcnt lgkmcnt(0)
    v_add_f32 v44, v44, v46
    v_add_f32 v45, v45, v47
    ds_swizzle_b32 v46, v44 offset:0x201f
    ds_swizzle_b32 v47, v45 offset:0x201f
    s_waitcnt lgkmcnt(0)
    v_add_f32 v44, v44, v46
    v_add_f32 v45, v45, v47
    ds_swizzle_b32 v46, v44 offset:0x401f
    ds_swizzle_b32 v47, v45 offset:0x401f
    s_waitcnt lgkmcnt(0)
    v_add_f32 v44, v44, v46
    v_add_f32 v45, v45, v47
    v_mov_b32 v46, v44
    v_mov_b32 v47, v45
    s_nop 1
    v_permlane32_swap_b32 v46, v44
    v_permlane32_swap_b32 v47, v45
    s_nop 1
    v_add_f32 v44, v44, v46
    v_add_f32 v45, v45, v47
    v_cmp_eq_u32 vcc, 1, v2
    s_nop 1
    v_cndmask_b32 v44, v44, v45, vcc
    s_mov_b32 s6, 0xbfb8aa3b
    v_mul_f32 v44, s6, v44
    v_exp_f32 v44, v44
    s_nop 0
    v_add_f32 v44, 1.0, v44
    v_rcp_f32 v44, v44
    s_lshl_b32 s6, s97, 1
    v_add_u32 v243, s6, v2
    v_lshlrev_b32 v243, 2, v243
    v_cmp_gt_u32 vcc, 2, v2
    s_and_saveexec_b64 s[90:91], vcc
    buffer_store_dword v44, v243, s[32:35], 0 offen
    s_mov_b64 exec, s[90:91]
    s_cmp_ge_u32 s97, 256
    s_cbranch_scc1 K1_NOFLAG
    s_add_u32 s40, s88, 0x1100000
    s_addc_u32 s41, s89, 0
    s_and_b32 s41, s41, 0xffff
    s_mov_b32 s42, 0x10000
    s_mov_b32 s43, 0x00020000
    v_mov_b32 v60, 0
    v_mov_b32 v61, 0
    v_mov_b32 v62, 0
    v_mov_b32 v63, 0
    s_lshl_b32 s6, s97, 7
    v_lshlrev_b32 v59, 4, v2
    v_add_u32 v59, s6, v59
    v_cmp_gt_u32 vcc, 2, v2
    s_and_saveexec_b64 s[90:91], vcc
    buffer_store_dwordx4 v[60:63], v59, s[40:43], 0 offen
    s_mov_b64 exec, s[90:91]
K1_NOFLAG:
    v_lshrrev_b32 v240, 4, v2
    v_lshlrev_b32 v241, 4, v240
    v_bfe_u32 v242, v2, 2, 2
    v_add_u32 v241, v241, v242
    v_lshlrev_b32 v241, 5, v241
    v_and_b32 v242, 3, v2
    v_lshlrev_b32 v242, 3, v242
    s_lshl_b32 s6, s3, 12
    s_add_u32 s6, s6, 0x1a000
    v_add3_u32 v241, v241, v242, s6
    ds_read_b64_tr_b16 v[48:49], v241 offset:0
    ds_read_b64_tr_b16 v[50:51], v241 offset:128
    ds_read_b64_tr_b16 v[52:53], v241 offset:256
    ds_read_b64_tr_b16 v[54:55], v241 offset:384
    v_and_b32 v241, 15, v2
    v_and_b32 v242, 7, v241
    v_lshlrev_b32 v240, 1, v240
    v_xor_b32 v242, v242, v240
    v_lshlrev_b32 v241, 7, v241
    s_add_u32 s6, s6, 2048
    v_add_u32 v241, s6, v241
    v_lshl_add_u32 v243, v242, 4, v241
    v_xor_b32 v242, 1, v242
    v_lshl_add_u32 v242, v242, 4, v241
    s_waitcnt lgkmcnt(0)
    ds_write_b128 v243, v[48:51]
    ds_write_b128 v242, v[52:55]
    v_lshrrev_b32 v240, 3, v2
    v_and_b32 v241, 7, v2
    v_lshlrev_b32 v242, 7, v240
    v_lshl_add_u32 v242, v241, 4, v242
    v_add_u32 v242, s6, v242
    s_waitcnt lgkmcnt(0)
    ds_read_b128 v[48:51], v242
    ds_read_b128 v[52:55], v242 offset:1024
    v_xor_b32 v241, v241, v240
    v_lshlrev_b32 v241, 4, v241
    s_mov_b32 s7, 11776
    v_mul_lo_u32 v240, v240, s7
    v_add_u32 v241, v241, v240
    s_and_b32 s6, s86, 31
    s_mul_i32 s6, s6, 188416
    s_lshr_b32 s7, s86, 5
    s_lshl_b32 s7, s7, 7
    s_add_u32 s6, s6, s7
    s_add_u32 s6, s6, 8192
    s_add_u32 s7, s6, 94208
    s_waitcnt lgkmcnt(0)
    s_cmp_ge_u32 s97, 896
    s_cbranch_scc1 K1_NOWD
    buffer_store_dwordx4 v[48:51], v241, s[24:27], s6 offen sc0 sc1
    buffer_store_dwordx4 v[52:55], v241, s[24:27], s7 offen sc0 sc1
K1_NOWD:
    s_waitcnt lgkmcnt(0)
    s_barrier
    s_add_u32 s20, s88, 0x800000
    s_addc_u32 s21, s89, 0
    s_and_b32 s21, s21, 0xffff
    s_mov_b32 s22, 0x800000
    s_mov_b32 s23, 0x00020000
    s_cmp_eq_u32 s100, 1
    s_cbranch_scc1 K1_STC
    s_branch K1_STB
K1_COMP:
    s_lshl_b32 s86, s3, 5
    v_and_b32 v240, 31, v2
    v_lshrrev_b32 v241, 1, v240
    v_and_b32 v241, 7, v241
    v_lshrrev_b32 v242, 5, v2
    v_xor_b32 v241, v241, v242
    v_lshlrev_b32 v241, 4, v241
    v_add_u32 v240, s86, v240
    v_lshlrev_b32 v240, 7, v240
    v_xor_b32 v243, 0, v241
    v_add_u32 v8, v243, v240
    v_xor_b32 v243, 32, v241
    v_add_u32 v9, v243, v240
    v_xor_b32 v243, 64, v241
    v_add_u32 v10, v243, v240
    v_xor_b32 v243, 96, v241
    v_add_u32 v11, v243, v240
    s_waitcnt lgkmcnt(0)
    s_add_u32 s20, s88, 0x800000
    s_addc_u32 s21, s89, 0
    s_and_b32 s21, s21, 0xffff
    s_mov_b32 s22, 0x800000
    s_mov_b32 s23, 0x00020000
    s_mov_b32 s24, s88
    s_mov_b32 s25, s89
    s_and_b32 s25, s25, 0xffff
    s_mov_b32 s26, 0x5c0000
    s_mov_b32 s27, 0x00020000
    s_lshl_b32 s6, s96, 7
    s_add_u32 s6, s6, s86
    v_and_b32 v240, 31, v2
    v_add_u32 v241, s6, v240
    v_lshlrev_b32 v241, 12, v241
    v_lshrrev_b32 v242, 5, v2
    v_lshlrev_b32 v242, 4, v242
    s_lshl_b32 s7, s98, 1
    v_add3_u32 v1, v241, v242, s7
    s_mov_b32 s7, 11776
    v_mul_lo_u32 v240, v240, s7
    s_lshl_b32 s6, s6, 1
    v_add3_u32 v1, v240, v242, s6
    s_cmp_eq_u32 s100, 1
    s_cbranch_scc1 K1_CC
    s_lshr_b32 s101, s3, 1
    s_and_b32 s84, s3, 1
    v_and_b32 v240, 15, v2
    v_lshrrev_b32 v241, 1, v240
    v_lshrrev_b32 v242, 4, v2
    v_xor_b32 v241, v241, v242
    v_lshlrev_b32 v241, 4, v241
    v_lshlrev_b32 v242, 7, v240
    s_lshl_b32 s6, s84, 13
    s_mul_i32 s7, s101, 2048
    s_add_u32 s7, s7, 0xc000
    v_xor_b32 v243, 0, v241
    v_add3_u32 v8, v243, v242, s6
    v_add3_u32 v10, v243, v242, s7
    v_xor_b32 v243, 64, v241
    v_add3_u32 v9, v243, v242, s6
    v_add3_u32 v11, v243, v242, s7
    v_lshrrev_b32 v240, 4, v2
    v_bfe_u32 v241, v2, 2, 2
    v_lshl_add_u32 v242, v240, 3, v241
    s_movk_i32 s6, 256
    v_mul_lo_u32 v242, v242, s6
    v_and_b32 v243, 1, v2
    v_lshl_add_u32 v242, v243, 3, v242
    v_add_u32 v242, 16384, v242
    v_and_b32 v240, 1, v240
    v_lshlrev_b32 v241, 2, v241
    v_lshl_add_u32 v241, v240, 1, v241
    v_bfe_u32 v240, v2, 1, 1
    v_xor_b32 v241, v241, v240
    s_mul_i32 s6, s101, 8
    s_add_u32 s7, s6, 0
    v_xor_b32 v243, s7, v241
    v_lshl_add_u32 v4, v243, 4, v242
    s_add_u32 s7, s6, 2
    v_xor_b32 v243, s7, v241
    v_lshl_add_u32 v5, v243, 4, v242
    s_add_u32 s7, s6, 4
    v_xor_b32 v243, s7, v241
    v_lshl_add_u32 v6, v243, 4, v242
    s_add_u32 s7, s6, 6
    v_xor_b32 v243, s7, v241
    v_lshl_add_u32 v7, v243, 4, v242
    s_barrier
    v_add_u32 v244, 0x0, v4
    v_add_u32 v245, 0x0, v5
    v_add_u32 v246, 0x0, v6
    v_add_u32 v247, 0x0, v7
    v_add_u32 v248, 0x0, v8
    v_add_u32 v250, 0x0, v10
    v_add_u32 v249, 0x0, v9
    v_add_u32 v251, 0x0, v11
    ds_read_b128 v[16:19], v248 offset:0
    ds_read_b128 v[20:23], v248 offset:2048
    ds_read_b128 v[24:27], v248 offset:4096
    ds_read_b128 v[28:31], v248 offset:6144
    ds_read_b64_tr_b16 v[48:49], v244 offset:0
    ds_read_b64_tr_b16 v[50:51], v244 offset:1024
    ds_read_b64_tr_b16 v[52:53], v245 offset:0
    ds_read_b64_tr_b16 v[54:55], v245 offset:1024
    ds_read_b64_tr_b16 v[56:57], v246 offset:0
    ds_read_b64_tr_b16 v[58:59], v246 offset:1024
    ds_read_b64_tr_b16 v[60:61], v247 offset:0
    ds_read_b64_tr_b16 v[62:63], v247 offset:1024
    ds_read_b64_tr_b16 v[64:65], v244 offset:16384
    ds_read_b64_tr_b16 v[66:67], v244 offset:17408
    ds_read_b64_tr_b16 v[68:69], v245 offset:16384
    ds_read_b64_tr_b16 v[70:71], v245 offset:17408
    ds_read_b64_tr_b16 v[72:73], v246 offset:16384
    ds_read_b64_tr_b16 v[74:75], v246 offset:17408
    ds_read_b64_tr_b16 v[76:77], v247 offset:16384
    ds_read_b64_tr_b16 v[78:79], v247 offset:17408
    ds_read_b128 v[80:83], v250 offset:0
    s_waitcnt lgkmcnt(15)
    s_waitcnt lgkmcnt(15)
    v_mfma_f32_16x16x32_bf16 v[96:99], v[48:51], v[16:19], 0
    v_mfma_f32_16x16x32_bf16 v[100:103], v[48:51], v[20:23], 0
    v_mfma_f32_16x16x32_bf16 v[104:107], v[48:51], v[24:27], 0
    v_mfma_f32_16x16x32_bf16 v[108:111], v[48:51], v[28:31], 0
    ds_read_b64_tr_b16 v[48:49], v244 offset:8192
    ds_read_b64_tr_b16 v[50:51], v244 offset:9216
    s_waitcnt lgkmcnt(15)
    v_mfma_f32_16x16x32_bf16 v[112:115], v[52:55], v[16:19], 0
    ds_read_b128 v[32:35], v249 offset:0
    v_mfma_f32_16x16x32_bf16 v[116:119], v[52:55], v[20:23], 0
    ds_read_b128 v[36:39], v249 offset:2048
    v_mfma_f32_16x16x32_bf16 v[120:123], v[52:55], v[24:27], 0
    ds_read_b128 v[40:43], v249 offset:4096
    v_mfma_f32_16x16x32_bf16 v[124:127], v[52:55], v[28:31], 0
    ds_read_b128 v[44:47], v249 offset:6144
    ds_read_b64_tr_b16 v[52:53], v245 offset:8192
    ds_read_b64_tr_b16 v[54:55], v245 offset:9216
    s_waitcnt lgkmcnt(15)
    v_mfma_f32_16x16x32_bf16 v[128:131], v[56:59], v[16:19], 0
    v_mfma_f32_16x16x32_bf16 v[132:135], v[56:59], v[20:23], 0
    v_mfma_f32_16x16x32_bf16 v[136:139], v[56:59], v[24:27], 0
    v_mfma_f32_16x16x32_bf16 v[140:143], v[56:59], v[28:31], 0
    ds_read_b64_tr_b16 v[56:57], v246 offset:8192
    ds_read_b64_tr_b16 v[58:59], v246 offset:9216
    s_waitcnt lgkmcnt(15)
    v_mfma_f32_16x16x32_bf16 v[144:147], v[60:63], v[16:19], 0
    v_mfma_f32_16x16x32_bf16 v[148:151], v[60:63], v[20:23], 0
    v_mfma_f32_16x16x32_bf16 v[152:155], v[60:63], v[24:27], 0
    v_mfma_f32_16x16x32_bf16 v[156:159], v[60:63], v[28:31], 0
    ds_read_b64_tr_b16 v[60:61], v247 offset:8192
    ds_read_b64_tr_b16 v[62:63], v247 offset:9216
    s_waitcnt lgkmcnt(15)
    v_mfma_f32_16x16x32_bf16 v[160:163], v[64:67], v[16:19], 0
    v_mfma_f32_16x16x32_bf16 v[164:167], v[64:67], v[20:23], 0
    v_mfma_f32_16x16x32_bf16 v[168:171], v[64:67], v[24:27], 0
    v_mfma_f32_16x16x32_bf16 v[172:175], v[64:67], v[28:31], 0
    ds_read_b64_tr_b16 v[64:65], v244 offset:24576
    ds_read_b64_tr_b16 v[66:67], v244 offset:25600
    s_waitcnt lgkmcnt(15)
    v_mfma_f32_16x16x32_bf16 v[176:179], v[68:71], v[16:19], 0
    v_mfma_f32_16x16x32_bf16 v[180:183], v[68:71], v[20:23], 0
    v_mfma_f32_16x16x32_bf16 v[184:187], v[68:71], v[24:27], 0
    v_mfma_f32_16x16x32_bf16 v[188:191], v[68:71], v[28:31], 0
    ds_read_b64_tr_b16 v[68:69], v245 offset:24576
    ds_read_b64_tr_b16 v[70:71], v245 offset:25600
    s_waitcnt lgkmcnt(15)
    v_mfma_f32_16x16x32_bf16 v[192:195], v[72:75], v[16:19], 0
    v_mfma_f32_16x16x32_bf16 v[196:199], v[72:75], v[20:23], 0
    v_mfma_f32_16x16x32_bf16 v[200:203], v[72:75], v[24:27], 0
    v_mfma_f32_16x16x32_bf16 v[204:207], v[72:75], v[28:31], 0
    ds_read_b64_tr_b16 v[72:73], v246 offset:24576
    ds_read_b64_tr_b16 v[74:75], v246 offset:25600
    s_waitcnt lgkmcnt(15)
    v_mfma_f32_16x16x32_bf16 v[208:211], v[76:79], v[16:19], 0
    v_mfma_f32_16x16x32_bf16 v[212:215], v[76:79], v[20:23], 0
    v_mfma_f32_16x16x32_bf16 v[216:219], v[76:79], v[24:27], 0
    v_mfma_f32_16x16x32_bf16 v[220:223], v[76:79], v[28:31], 0
    ds_read_b64_tr_b16 v[76:77], v247 offset:24576
    ds_read_b64_tr_b16 v[78:79], v247 offset:25600
    s_waitcnt lgkmcnt(15)
    v_mfma_f32_16x16x32_bf16 v[224:227], v[16:19], v[80:83], 0
    v_mfma_f32_16x16x32_bf16 v[228:231], v[20:23], v[80:83], 0
    v_mfma_f32_16x16x32_bf16 v[232:235], v[24:27], v[80:83], 0
    v_mfma_f32_16x16x32_bf16 v[236:239], v[28:31], v[80:83], 0
    ds_read_b128 v[80:83], v251 offset:0
    s_waitcnt lgkmcnt(0)
    s_barrier
    v_mfma_f32_16x16x32_bf16 v[96:99], v[48:51], v[32:35], v[96:99]
    v_add_u32 v244, 0xd000, v4
    v_add_u32 v245, 0xd000, v5
    v_mfma_f32_16x16x32_bf16 v[100:103], v[48:51], v[36:39], v[100:103]
    v_add_u32 v246, 0xd000, v6
    v_add_u32 v247, 0xd000, v7
    v_mfma_f32_16x16x32_bf16 v[104:107], v[48:51], v[40:43], v[104:107]
    v_add_u32 v248, 0xd000, v8
    v_add_u32 v250, 0xd000, v10
    v_mfma_f32_16x16x32_bf16 v[108:111], v[48:51], v[44:47], v[108:111]
    v_add_u32 v249, 0xd000, v9
    v_add_u32 v251, 0xd000, v11
    ds_read_b64_tr_b16 v[48:49], v244 offset:0
    ds_read_b64_tr_b16 v[50:51], v244 offset:1024
    v_mfma_f32_16x16x32_bf16 v[112:115], v[52:55], v[32:35], v[112:115]
    ds_read_b128 v[16:19], v248 offset:0
    v_mfma_f32_16x16x32_bf16 v[116:119], v[52:55], v[36:39], v[116:119]
    ds_read_b128 v[20:23], v248 offset:2048
    v_mfma_f32_16x16x32_bf16 v[120:123], v[52:55], v[40:43], v[120:123]
    ds_read_b128 v[24:27], v248 offset:4096
    v_mfma_f32_16x16x32_bf16 v[124:127], v[52:55], v[44:47], v[124:127]
    ds_read_b128 v[28:31], v248 offset:6144
    ds_read_b64_tr_b16 v[52:53], v245 offset:0
    ds_read_b64_tr_b16 v[54:55], v245 offset:1024
    v_mfma_f32_16x16x32_bf16 v[128:131], v[56:59], v[32:35], v[128:131]
    v_mfma_f32_16x16x32_bf16 v[132:135], v[56:59], v[36:39], v[132:135]
    v_mfma_f32_16x16x32_bf16 v[136:139], v[56:59], v[40:43], v[136:139]
    v_mfma_f32_16x16x32_bf16 v[140:143], v[56:59], v[44:47], v[140:143]
    ds_read_b64_tr_b16 v[56:57], v246 offset:0
    ds_read_b64_tr_b16 v[58:59], v246 offset:1024
    v_mfma_f32_16x16x32_bf16 v[144:147], v[60:63], v[32:35], v[144:147]
    v_mfma_f32_16x16x32_bf16 v[148:151], v[60:63], v[36:39], v[148:151]
    v_mfma_f32_16x16x32_bf16 v[152:155], v[60:63], v[40:43], v[152:155]
    v_mfma_f32_16x16x32_bf16 v[156:159], v[60:63], v[44:47], v[156:159]
    ds_read_b64_tr_b16 v[60:61], v247 offset:0
    ds_read_b64_tr_b16 v[62:63], v247 offset:1024
    v_mfma_f32_16x16x32_bf16 v[160:163], v[64:67], v[32:35], v[160:163]
    v_mfma_f32_16x16x32_bf16 v[164:167], v[64:67], v[36:39], v[164:167]
    v_mfma_f32_16x16x32_bf16 v[168:171], v[64:67], v[40:43], v[168:171]
    v_mfma_f32_16x16x32_bf16 v[172:175], v[64:67], v[44:47], v[172:175]
    ds_read_b64_tr_b16 v[64:65], v244 offset:16384
    ds_read_b64_tr_b16 v[66:67], v244 offset:17408
    v_mfma_f32_16x16x32_bf16 v[176:179], v[68:71], v[32:35], v[176:179]
    v_mfma_f32_16x16x32_bf16 v[180:183], v[68:71], v[36:39], v[180:183]
    v_mfma_f32_16x16x32_bf16 v[184:187], v[68:71], v[40:43], v[184:187]
    v_mfma_f32_16x16x32_bf16 v[188:191], v[68:71], v[44:47], v[188:191]
    ds_read_b64_tr_b16 v[68:69], v245 offset:16384
    ds_read_b64_tr_b16 v[70:71], v245 offset:17408
    v_mfma_f32_16x16x32_bf16 v[192:195], v[72:75], v[32:35], v[192:195]
    v_mfma_f32_16x16x32_bf16 v[196:199], v[72:75], v[36:39], v[196:199]
    v_mfma_f32_16x16x32_bf16 v[200:203], v[72:75], v[40:43], v[200:203]
    v_mfma_f32_16x16x32_bf16 v[204:207], v[72:75], v[44:47], v[204:207]
    ds_read_b64_tr_b16 v[72:73], v246 offset:16384
    ds_read_b64_tr_b16 v[74:75], v246 offset:17408
    v_mfma_f32_16x16x32_bf16 v[208:211], v[76:79], v[32:35], v[208:211]
    v_mfma_f32_16x16x32_bf16 v[212:215], v[76:79], v[36:39], v[212:215]
    v_mfma_f32_16x16x32_bf16 v[216:219], v[76:79], v[40:43], v[216:219]
    v_mfma_f32_16x16x32_bf16 v[220:223], v[76:79], v[44:47], v[220:223]
    ds_read_b64_tr_b16 v[76:77], v247 offset:16384
    ds_read_b64_tr_b16 v[78:79], v247 offset:17408
    v_mfma_f32_16x16x32_bf16 v[224:227], v[32:35], v[80:83], v[224:227]
    v_mfma_f32_16x16x32_bf16 v[228:231], v[36:39], v[80:83], v[228:231]
    v_mfma_f32_16x16x32_bf16 v[232:235], v[40:43], v[80:83], v[232:235]
    v_mfma_f32_16x16x32_bf16 v[236:239], v[44:47], v[80:83], v[236:239]
    ds_read_b128 v[80:83], v250 offset:0
    s_waitcnt lgkmcnt(15)
    v_mfma_f32_16x16x32_bf16 v[96:99], v[48:51], v[16:19], v[96:99]
    v_mfma_f32_16x16x32_bf16 v[100:103], v[48:51], v[20:23], v[100:103]
    v_mfma_f32_16x16x32_bf16 v[104:107], v[48:51], v[24:27], v[104:107]
    v_mfma_f32_16x16x32_bf16 v[108:111], v[48:51], v[28:31], v[108:111]
    ds_read_b64_tr_b16 v[48:49], v244 offset:8192
    ds_read_b64_tr_b16 v[50:51], v244 offset:9216
    s_waitcnt lgkmcnt(15)
    v_mfma_f32_16x16x32_bf16 v[112:115], v[52:55], v[16:19], v[112:115]
    ds_read_b128 v[32:35], v249 offset:0
    v_mfma_f32_16x16x32_bf16 v[116:119], v[52:55], v[20:23], v[116:119]
    ds_read_b128 v[36:39], v249 offset:2048
    v_mfma_f32_16x16x32_bf16 v[120:123], v[52:55], v[24:27], v[120:123]
    ds_read_b128 v[40:43], v249 offset:4096
    v_mfma_f32_16x16x32_bf16 v[124:127], v[52:55], v[28:31], v[124:127]
    ds_read_b128 v[44:47], v249 offset:6144
    ds_read_b64_tr_b16 v[52:53], v245 offset:8192
    ds_read_b64_tr_b16 v[54:55], v245 offset:9216
    s_waitcnt lgkmcnt(15)
    v_mfma_f32_16x16x32_bf16 v[128:131], v[56:59], v[16:19], v[128:131]
    v_mfma_f32_16x16x32_bf16 v[132:135], v[56:59], v[20:23], v[132:135]
    v_mfma_f32_16x16x32_bf16 v[136:139], v[56:59], v[24:27], v[136:139]
    v_mfma_f32_16x16x32_bf16 v[140:143], v[56:59], v[28:31], v[140:143]
    ds_read_b64_tr_b16 v[56:57], v246 offset:8192
    ds_read_b64_tr_b16 v[58:59], v246 offset:9216
    s_waitcnt lgkmcnt(15)
    v_mfma_f32_16x16x32_bf16 v[144:147], v[60:63], v[16:19], v[144:147]
    v_mfma_f32_16x16x32_bf16 v[148:151], v[60:63], v[20:23], v[148:151]
    v_mfma_f32_16x16x32_bf16 v[152:155], v[60:63], v[24:27], v[152:155]
    v_mfma_f32_16x16x32_bf16 v[156:159], v[60:63], v[28:31], v[156:159]
    ds_read_b64_tr_b16 v[60:61], v247 offset:8192
    ds_read_b64_tr_b16 v[62:63], v247 offset:9216
    s_waitcnt lgkmcnt(15)
    v_mfma_f32_16x16x32_bf16 v[160:163], v[64:67], v[16:19], v[160:163]
    v_mfma_f32_16x16x32_bf16 v[164:167], v[64:67], v[20:23], v[164:167]
    v_mfma_f32_16x16x32_bf16 v[168:171], v[64:67], v[24:27], v[168:171]
    v_mfma_f32_16x16x32_bf16 v[172:175], v[64:67], v[28:31], v[172:175]
    ds_read_b64_tr_b16 v[64:65], v244 offset:24576
    ds_read_b64_tr_b16 v[66:67], v244 offset:25600
    s_waitcnt lgkmcnt(15)
    v_mfma_f32_16x16x32_bf16 v[176:179], v[68:71], v[16:19], v[176:179]
    v_mfma_f32_16x16x32_bf16 v[180:183], v[68:71], v[20:23], v[180:183]
    v_mfma_f32_16x16x32_bf16 v[184:187], v[68:71], v[24:27], v[184:187]
    v_mfma_f32_16x16x32_bf16 v[188:191], v[68:71], v[28:31], v[188:191]
    ds_read_b64_tr_b16 v[68:69], v245 offset:24576
    ds_read_b64_tr_b16 v[70:71], v245 offset:25600
    s_waitcnt lgkmcnt(15)
    v_mfma_f32_16x16x32_bf16 v[192:195], v[72:75], v[16:19], v[192:195]
    v_mfma_f32_16x16x32_bf16 v[196:199], v[72:75], v[20:23], v[196:199]
    v_mfma_f32_16x16x32_bf16 v[200:203], v[72:75], v[24:27], v[200:203]
    v_mfma_f32_16x16x32_bf16 v[204:207], v[72:75], v[28:31], v[204:207]
    ds_read_b64_tr_b16 v[72:73], v246 offset:24576
    ds_read_b64_tr_b16 v[74:75], v246 offset:25600
    s_waitcnt lgkmcnt(15)
    v_mfma_f32_16x16x32_bf16 v[208:211], v[76:79], v[16:19], v[208:211]
    v_mfma_f32_16x16x32_bf16 v[212:215], v[76:79], v[20:23], v[212:215]
    v_mfma_f32_16x16x32_bf16 v[216:219], v[76:79], v[24:27], v[216:219]
    v_mfma_f32_16x16x32_bf16 v[220:223], v[76:79], v[28:31], v[220:223]
    ds_read_b64_tr_b16 v[76:77], v247 offset:24576
    ds_read_b64_tr_b16 v[78:79], v247 offset:25600
    s_waitcnt lgkmcnt(15)
    v_mfma_f32_16x16x32_bf16 v[224:227], v[16:19], v[80:83], v[224:227]
    v_mfma_f32_16x16x32_bf16 v[228:231], v[20:23], v[80:83], v[228:231]
    v_mfma_f32_16x16x32_bf16 v[232:235], v[24:27], v[80:83], v[232:235]
    v_mfma_f32_16x16x32_bf16 v[236:239], v[28:31], v[80:83], v[236:239]
    ds_read_b128 v[80:83], v251 offset:0
    s_waitcnt lgkmcnt(0)
    s_barrier
    v_mfma_f32_16x16x32_bf16 v[96:99], v[48:51], v[32:35], v[96:99]
    v_add_u32 v244, 0x1a000, v4
    v_add_u32 v245, 0x1a000, v5
    v_mfma_f32_16x16x32_bf16 v[100:103], v[48:51], v[36:39], v[100:103]
    v_add_u32 v246, 0x1a000, v6
    v_add_u32 v247, 0x1a000, v7
    v_mfma_f32_16x16x32_bf16 v[104:107], v[48:51], v[40:43], v[104:107]
    v_add_u32 v248, 0x1a000, v8
    v_add_u32 v250, 0x1a000, v10
    v_mfma_f32_16x16x32_bf16 v[108:111], v[48:51], v[44:47], v[108:111]
    v_add_u32 v249, 0x1a000, v9
    v_add_u32 v251, 0x1a000, v11
    ds_read_b64_tr_b16 v[48:49], v244 offset:0
    ds_read_b64_tr_b16 v[50:51], v244 offset:1024
    v_mfma_f32_16x16x32_bf16 v[112:115], v[52:55], v[32:35], v[112:115]
    ds_read_b128 v[16:19], v248 offset:0
    v_mfma_f32_16x16x32_bf16 v[116:119], v[52:55], v[36:39], v[116:119]
    ds_read_b128 v[20:23], v248 offset:2048
    v_mfma_f32_16x16x32_bf16 v[120:123], v[52:55], v[40:43], v[120:123]
    ds_read_b128 v[24:27], v248 offset:4096
    v_mfma_f32_16x16x32_bf16 v[124:127], v[52:55], v[44:47], v[124:127]
    ds_read_b128 v[28:31], v248 offset:6144
    ds_read_b64_tr_b16 v[52:53], v245 offset:0
    ds_read_b64_tr_b16 v[54:55], v245 offset:1024
    v_mfma_f32_16x16x32_bf16 v[128:131], v[56:59], v[32:35], v[128:131]
    v_mfma_f32_16x16x32_bf16 v[132:135], v[56:59], v[36:39], v[132:135]
    v_mfma_f32_16x16x32_bf16 v[136:139], v[56:59], v[40:43], v[136:139]
    v_mfma_f32_16x16x32_bf16 v[140:143], v[56:59], v[44:47], v[140:143]
    ds_read_b64_tr_b16 v[56:57], v246 offset:0
    ds_read_b64_tr_b16 v[58:59], v246 offset:1024
    v_mfma_f32_16x16x32_bf16 v[144:147], v[60:63], v[32:35], v[144:147]
    v_mfma_f32_16x16x32_bf16 v[148:151], v[60:63], v[36:39], v[148:151]
    v_mfma_f32_16x16x32_bf16 v[152:155], v[60:63], v[40:43], v[152:155]
    v_mfma_f32_16x16x32_bf16 v[156:159], v[60:63], v[44:47], v[156:159]
    ds_read_b64_tr_b16 v[60:61], v247 offset:0
    ds_read_b64_tr_b16 v[62:63], v247 offset:1024
    v_mfma_f32_16x16x32_bf16 v[160:163], v[64:67], v[32:35], v[160:163]
    v_mfma_f32_16x16x32_bf16 v[164:167], v[64:67], v[36:39], v[164:167]
    v_mfma_f32_16x16x32_bf16 v[168:171], v[64:67], v[40:43], v[168:171]
    v_mfma_f32_16x16x32_bf16 v[172:175], v[64:67], v[44:47], v[172:175]
    ds_read_b64_tr_b16 v[64:65], v244 offset:16384
    ds_read_b64_tr_b16 v[66:67], v244 offset:17408
    v_mfma_f32_16x16x32_bf16 v[176:179], v[68:71], v[32:35], v[176:179]
    v_mfma_f32_16x16x32_bf16 v[180:183], v[68:71], v[36:39], v[180:183]
    v_mfma_f32_16x16x32_bf16 v[184:187], v[68:71], v[40:43], v[184:187]
    v_mfma_f32_16x16x32_bf16 v[188:191], v[68:71], v[44:47], v[188:191]
    ds_read_b64_tr_b16 v[68:69], v245 offset:16384
    ds_read_b64_tr_b16 v[70:71], v245 offset:17408
    v_mfma_f32_16x16x32_bf16 v[192:195], v[72:75], v[32:35], v[192:195]
    v_mfma_f32_16x16x32_bf16 v[196:199], v[72:75], v[36:39], v[196:199]
    v_mfma_f32_16x16x32_bf16 v[200:203], v[72:75], v[40:43], v[200:203]
    v_mfma_f32_16x16x32_bf16 v[204:207], v[72:75], v[44:47], v[204:207]
    ds_read_b64_tr_b16 v[72:73], v246 offset:16384
    ds_read_b64_tr_b16 v[74:75], v246 offset:17408
    v_mfma_f32_16x16x32_bf16 v[208:211], v[76:79], v[32:35], v[208:211]
    v_mfma_f32_16x16x32_bf16 v[212:215], v[76:79], v[36:39], v[212:215]
    v_mfma_f32_16x16x32_bf16 v[216:219], v[76:79], v[40:43], v[216:219]
    v_mfma_f32_16x16x32_bf16 v[220:223], v[76:79], v[44:47], v[220:223]
    ds_read_b64_tr_b16 v[76:77], v247 offset:16384
    ds_read_b64_tr_b16 v[78:79], v247 offset:17408
    v_mfma_f32_16x16x32_bf16 v[224:227], v[32:35], v[80:83], v[224:227]
    v_mfma_f32_16x16x32_bf16 v[228:231], v[36:39], v[80:83], v[228:231]
    v_mfma_f32_16x16x32_bf16 v[232:235], v[40:43], v[80:83], v[232:235]
    v_mfma_f32_16x16x32_bf16 v[236:239], v[44:47], v[80:83], v[236:239]
    ds_read_b128 v[80:83], v250 offset:0
    s_waitcnt lgkmcnt(15)
    v_mfma_f32_16x16x32_bf16 v[96:99], v[48:51], v[16:19], v[96:99]
    v_mfma_f32_16x16x32_bf16 v[100:103], v[48:51], v[20:23], v[100:103]
    v_mfma_f32_16x16x32_bf16 v[104:107], v[48:51], v[24:27], v[104:107]
    v_mfma_f32_16x16x32_bf16 v[108:111], v[48:51], v[28:31], v[108:111]
    ds_read_b64_tr_b16 v[48:49], v244 offset:8192
    ds_read_b64_tr_b16 v[50:51], v244 offset:9216
    s_waitcnt lgkmcnt(15)
    v_mfma_f32_16x16x32_bf16 v[112:115], v[52:55], v[16:19], v[112:115]
    ds_read_b128 v[32:35], v249 offset:0
    v_mfma_f32_16x16x32_bf16 v[116:119], v[52:55], v[20:23], v[116:119]
    ds_read_b128 v[36:39], v249 offset:2048
    v_mfma_f32_16x16x32_bf16 v[120:123], v[52:55], v[24:27], v[120:123]
    ds_read_b128 v[40:43], v249 offset:4096
    v_mfma_f32_16x16x32_bf16 v[124:127], v[52:55], v[28:31], v[124:127]
    ds_read_b128 v[44:47], v249 offset:6144
    ds_read_b64_tr_b16 v[52:53], v245 offset:8192
    ds_read_b64_tr_b16 v[54:55], v245 offset:9216
    s_waitcnt lgkmcnt(15)
    v_mfma_f32_16x16x32_bf16 v[128:131], v[56:59], v[16:19], v[128:131]
    v_mfma_f32_16x16x32_bf16 v[132:135], v[56:59], v[20:23], v[132:135]
    v_mfma_f32_16x16x32_bf16 v[136:139], v[56:59], v[24:27], v[136:139]
    v_mfma_f32_16x16x32_bf16 v[140:143], v[56:59], v[28:31], v[140:143]
    ds_read_b64_tr_b16 v[56:57], v246 offset:8192
    ds_read_b64_tr_b16 v[58:59], v246 offset:9216
    s_waitcnt lgkmcnt(15)
    v_mfma_f32_16x16x32_bf16 v[144:147], v[60:63], v[16:19], v[144:147]
    v_mfma_f32_16x16x32_bf16 v[148:151], v[60:63], v[20:23], v[148:151]
    v_mfma_f32_16x16x32_bf16 v[152:155], v[60:63], v[24:27], v[152:155]
    v_mfma_f32_16x16x32_bf16 v[156:159], v[60:63], v[28:31], v[156:159]
    ds_read_b64_tr_b16 v[60:61], v247 offset:8192
    ds_read_b64_tr_b16 v[62:63], v247 offset:9216
    s_waitcnt lgkmcnt(15)
    v_mfma_f32_16x16x32_bf16 v[160:163], v[64:67], v[16:19], v[160:163]
    v_mfma_f32_16x16x32_bf16 v[164:167], v[64:67], v[20:23], v[164:167]
    v_mfma_f32_16x16x32_bf16 v[168:171], v[64:67], v[24:27], v[168:171]
    v_mfma_f32_16x16x32_bf16 v[172:175], v[64:67], v[28:31], v[172:175]
    ds_read_b64_tr_b16 v[64:65], v244 offset:24576
    ds_read_b64_tr_b16 v[66:67], v244 offset:25600
    s_waitcnt lgkmcnt(15)
    v_mfma_f32_16x16x32_bf16 v[176:179], v[68:71], v[16:19], v[176:179]
    v_mfma_f32_16x16x32_bf16 v[180:183], v[68:71], v[20:23], v[180:183]
    v_mfma_f32_16x16x32_bf16 v[184:187], v[68:71], v[24:27], v[184:187]
    v_mfma_f32_16x16x32_bf16 v[188:191], v[68:71], v[28:31], v[188:191]
    ds_read_b64_tr_b16 v[68:69], v245 offset:24576
    ds_read_b64_tr_b16 v[70:71], v245 offset:25600
    s_waitcnt lgkmcnt(15)
    v_mfma_f32_16x16x32_bf16 v[192:195], v[72:75], v[16:19], v[192:195]
    v_mfma_f32_16x16x32_bf16 v[196:199], v[72:75], v[20:23], v[196:199]
    v_mfma_f32_16x16x32_bf16 v[200:203], v[72:75], v[24:27], v[200:203]
    v_mfma_f32_16x16x32_bf16 v[204:207], v[72:75], v[28:31], v[204:207]
    ds_read_b64_tr_b16 v[72:73], v246 offset:24576
    ds_read_b64_tr_b16 v[74:75], v246 offset:25600
    s_waitcnt lgkmcnt(15)
    v_mfma_f32_16x16x32_bf16 v[208:211], v[76:79], v[16:19], v[208:211]
    v_mfma_f32_16x16x32_bf16 v[212:215], v[76:79], v[20:23], v[212:215]
    v_mfma_f32_16x16x32_bf16 v[216:219], v[76:79], v[24:27], v[216:219]
    v_mfma_f32_16x16x32_bf16 v[220:223], v[76:79], v[28:31], v[220:223]
    ds_read_b64_tr_b16 v[76:77], v247 offset:24576
    ds_read_b64_tr_b16 v[78:79], v247 offset:25600
    s_waitcnt lgkmcnt(15)
    v_mfma_f32_16x16x32_bf16 v[224:227], v[16:19], v[80:83], v[224:227]
    v_mfma_f32_16x16x32_bf16 v[228:231], v[20:23], v[80:83], v[228:231]
    v_mfma_f32_16x16x32_bf16 v[232:235], v[24:27], v[80:83], v[232:235]
    v_mfma_f32_16x16x32_bf16 v[236:239], v[28:31], v[80:83], v[236:239]
    ds_read_b128 v[80:83], v251 offset:0
    s_waitcnt lgkmcnt(0)
    s_barrier
    v_mfma_f32_16x16x32_bf16 v[96:99], v[48:51], v[32:35], v[96:99]
    v_add_u32 v244, 0x0, v4
    v_add_u32 v245, 0x0, v5
    v_mfma_f32_16x16x32_bf16 v[100:103], v[48:51], v[36:39], v[100:103]
    v_add_u32 v246, 0x0, v6
    v_add_u32 v247, 0x0, v7
    v_mfma_f32_16x16x32_bf16 v[104:107], v[48:51], v[40:43], v[104:107]
    v_add_u32 v248, 0x0, v8
    v_add_u32 v250, 0x0, v10
    v_mfma_f32_16x16x32_bf16 v[108:111], v[48:51], v[44:47], v[108:111]
    v_add_u32 v249, 0x0, v9
    v_add_u32 v251, 0x0, v11
    ds_read_b64_tr_b16 v[48:49], v244 offset:0
    ds_read_b64_tr_b16 v[50:51], v244 offset:1024
    v_mfma_f32_16x16x32_bf16 v[112:115], v[52:55], v[32:35], v[112:115]
    ds_read_b128 v[16:19], v248 offset:0
    v_mfma_f32_16x16x32_bf16 v[116:119], v[52:55], v[36:39], v[116:119]
    ds_read_b128 v[20:23], v248 offset:2048
    v_mfma_f32_16x16x32_bf16 v[120:123], v[52:55], v[40:43], v[120:123]
    ds_read_b128 v[24:27], v248 offset:4096
    v_mfma_f32_16x16x32_bf16 v[124:127], v[52:55], v[44:47], v[124:127]
    ds_read_b128 v[28:31], v248 offset:6144
    ds_read_b64_tr_b16 v[52:53], v245 offset:0
    ds_read_b64_tr_b16 v[54:55], v245 offset:1024
    v_mfma_f32_16x16x32_bf16 v[128:131], v[56:59], v[32:35], v[128:131]
    v_mfma_f32_16x16x32_bf16 v[132:135], v[56:59], v[36:39], v[132:135]
    v_mfma_f32_16x16x32_bf16 v[136:139], v[56:59], v[40:43], v[136:139]
    v_mfma_f32_16x16x32_bf16 v[140:143], v[56:59], v[44:47], v[140:143]
    ds_read_b64_tr_b16 v[56:57], v246 offset:0
    ds_read_b64_tr_b16 v[58:59], v246 offset:1024
    v_mfma_f32_16x16x32_bf16 v[144:147], v[60:63], v[32:35], v[144:147]
    v_mfma_f32_16x16x32_bf16 v[148:151], v[60:63], v[36:39], v[148:151]
    v_mfma_f32_16x16x32_bf16 v[152:155], v[60:63], v[40:43], v[152:155]
    v_mfma_f32_16x16x32_bf16 v[156:159], v[60:63], v[44:47], v[156:159]
    ds_read_b64_tr_b16 v[60:61], v247 offset:0
    ds_read_b64_tr_b16 v[62:63], v247 offset:1024
    v_mfma_f32_16x16x32_bf16 v[160:163], v[64:67], v[32:35], v[160:163]
    v_mfma_f32_16x16x32_bf16 v[164:167], v[64:67], v[36:39], v[164:167]
    v_mfma_f32_16x16x32_bf16 v[168:171], v[64:67], v[40:43], v[168:171]
    v_mfma_f32_16x16x32_bf16 v[172:175], v[64:67], v[44:47], v[172:175]
    ds_read_b64_tr_b16 v[64:65], v244 offset:16384
    ds_read_b64_tr_b16 v[66:67], v244 offset:17408
    v_mfma_f32_16x16x32_bf16 v[176:179], v[68:71], v[32:35], v[176:179]
    v_mfma_f32_16x16x32_bf16 v[180:183], v[68:71], v[36:39], v[180:183]
    v_mfma_f32_16x16x32_bf16 v[184:187], v[68:71], v[40:43], v[184:187]
    v_mfma_f32_16x16x32_bf16 v[188:191], v[68:71], v[44:47], v[188:191]
    ds_read_b64_tr_b16 v[68:69], v245 offset:16384
    ds_read_b64_tr_b16 v[70:71], v245 offset:17408
    v_mfma_f32_16x16x32_bf16 v[192:195], v[72:75], v[32:35], v[192:195]
    v_mfma_f32_16x16x32_bf16 v[196:199], v[72:75], v[36:39], v[196:199]
    v_mfma_f32_16x16x32_bf16 v[200:203], v[72:75], v[40:43], v[200:203]
    v_mfma_f32_16x16x32_bf16 v[204:207], v[72:75], v[44:47], v[204:207]
    ds_read_b64_tr_b16 v[72:73], v246 offset:16384
    ds_read_b64_tr_b16 v[74:75], v246 offset:17408
    v_mfma_f32_16x16x32_bf16 v[208:211], v[76:79], v[32:35], v[208:211]
    v_mfma_f32_16x16x32_bf16 v[212:215], v[76:79], v[36:39], v[212:215]
    v_mfma_f32_16x16x32_bf16 v[216:219], v[76:79], v[40:43], v[216:219]
    v_mfma_f32_16x16x32_bf16 v[220:223], v[76:79], v[44:47], v[220:223]
    ds_read_b64_tr_b16 v[76:77], v247 offset:16384
    ds_read_b64_tr_b16 v[78:79], v247 offset:17408
    v_mfma_f32_16x16x32_bf16 v[224:227], v[32:35], v[80:83], v[224:227]
    v_mfma_f32_16x16x32_bf16 v[228:231], v[36:39], v[80:83], v[228:231]
    v_mfma_f32_16x16x32_bf16 v[232:235], v[40:43], v[80:83], v[232:235]
    v_mfma_f32_16x16x32_bf16 v[236:239], v[44:47], v[80:83], v[236:239]
    ds_read_b128 v[80:83], v250 offset:0
    s_waitcnt lgkmcnt(15)
    v_mfma_f32_16x16x32_bf16 v[96:99], v[48:51], v[16:19], v[96:99]
    v_mfma_f32_16x16x32_bf16 v[100:103], v[48:51], v[20:23], v[100:103]
    v_mfma_f32_16x16x32_bf16 v[104:107], v[48:51], v[24:27], v[104:107]
    v_mfma_f32_16x16x32_bf16 v[108:111], v[48:51], v[28:31], v[108:111]
    ds_read_b64_tr_b16 v[48:49], v244 offset:8192
    ds_read_b64_tr_b16 v[50:51], v244 offset:9216
    s_waitcnt lgkmcnt(15)
    v_mfma_f32_16x16x32_bf16 v[112:115], v[52:55], v[16:19], v[112:115]
    ds_read_b128 v[32:35], v249 offset:0
    v_mfma_f32_16x16x32_bf16 v[116:119], v[52:55], v[20:23], v[116:119]
    ds_read_b128 v[36:39], v249 offset:2048
    v_mfma_f32_16x16x32_bf16 v[120:123], v[52:55], v[24:27], v[120:123]
    ds_read_b128 v[40:43], v249 offset:4096
    v_mfma_f32_16x16x32_bf16 v[124:127], v[52:55], v[28:31], v[124:127]
    ds_read_b128 v[44:47], v249 offset:6144
    ds_read_b64_tr_b16 v[52:53], v245 offset:8192
    ds_read_b64_tr_b16 v[54:55], v245 offset:9216
    s_waitcnt lgkmcnt(15)
    v_mfma_f32_16x16x32_bf16 v[128:131], v[56:59], v[16:19], v[128:131]
    v_mfma_f32_16x16x32_bf16 v[132:135], v[56:59], v[20:23], v[132:135]
    v_mfma_f32_16x16x32_bf16 v[136:139], v[56:59], v[24:27], v[136:139]
    v_mfma_f32_16x16x32_bf16 v[140:143], v[56:59], v[28:31], v[140:143]
    ds_read_b64_tr_b16 v[56:57], v246 offset:8192
    ds_read_b64_tr_b16 v[58:59], v246 offset:9216
    s_waitcnt lgkmcnt(15)
    v_mfma_f32_16x16x32_bf16 v[144:147], v[60:63], v[16:19], v[144:147]
    v_mfma_f32_16x16x32_bf16 v[148:151], v[60:63], v[20:23], v[148:151]
    v_mfma_f32_16x16x32_bf16 v[152:155], v[60:63], v[24:27], v[152:155]
    v_mfma_f32_16x16x32_bf16 v[156:159], v[60:63], v[28:31], v[156:159]
    ds_read_b64_tr_b16 v[60:61], v247 offset:8192
    ds_read_b64_tr_b16 v[62:63], v247 offset:9216
    s_waitcnt lgkmcnt(15)
    v_mfma_f32_16x16x32_bf16 v[160:163], v[64:67], v[16:19], v[160:163]
    v_mfma_f32_16x16x32_bf16 v[164:167], v[64:67], v[20:23], v[164:167]
    v_mfma_f32_16x16x32_bf16 v[168:171], v[64:67], v[24:27], v[168:171]
    v_mfma_f32_16x16x32_bf16 v[172:175], v[64:67], v[28:31], v[172:175]
    ds_read_b64_tr_b16 v[64:65], v244 offset:24576
    ds_read_b64_tr_b16 v[66:67], v244 offset:25600
    s_waitcnt lgkmcnt(15)
    v_mfma_f32_16x16x32_bf16 v[176:179], v[68:71], v[16:19], v[176:179]
    v_mfma_f32_16x16x32_bf16 v[180:183], v[68:71], v[20:23], v[180:183]
    v_mfma_f32_16x16x32_bf16 v[184:187], v[68:71], v[24:27], v[184:187]
    v_mfma_f32_16x16x32_bf16 v[188:191], v[68:71], v[28:31], v[188:191]
    ds_read_b64_tr_b16 v[68:69], v245 offset:24576
    ds_read_b64_tr_b16 v[70:71], v245 offset:25600
    s_waitcnt lgkmcnt(15)
    v_mfma_f32_16x16x32_bf16 v[192:195], v[72:75], v[16:19], v[192:195]
    v_mfma_f32_16x16x32_bf16 v[196:199], v[72:75], v[20:23], v[196:199]
    v_mfma_f32_16x16x32_bf16 v[200:203], v[72:75], v[24:27], v[200:203]
    v_mfma_f32_16x16x32_bf16 v[204:207], v[72:75], v[28:31], v[204:207]
    ds_read_b64_tr_b16 v[72:73], v246 offset:24576
    ds_read_b64_tr_b16 v[74:75], v246 offset:25600
    s_waitcnt lgkmcnt(15)
    v_mfma_f32_16x16x32_bf16 v[208:211], v[76:79], v[16:19], v[208:211]
    v_mfma_f32_16x16x32_bf16 v[212:215], v[76:79], v[20:23], v[212:215]
    v_mfma_f32_16x16x32_bf16 v[216:219], v[76:79], v[24:27], v[216:219]
    v_mfma_f32_16x16x32_bf16 v[220:223], v[76:79], v[28:31], v[220:223]
    ds_read_b64_tr_b16 v[76:77], v247 offset:24576
    ds_read_b64_tr_b16 v[78:79], v247 offset:25600
    s_waitcnt lgkmcnt(15)
    v_mfma_f32_16x16x32_bf16 v[224:227], v[16:19], v[80:83], v[224:227]
    v_mfma_f32_16x16x32_bf16 v[228:231], v[20:23], v[80:83], v[228:231]
    v_mfma_f32_16x16x32_bf16 v[232:235], v[24:27], v[80:83], v[232:235]
    v_mfma_f32_16x16x32_bf16 v[236:239], v[28:31], v[80:83], v[236:239]
    ds_read_b128 v[80:83], v251 offset:0
    s_waitcnt lgkmcnt(0)
    s_barrier
    v_mfma_f32_16x16x32_bf16 v[96:99], v[48:51], v[32:35], v[96:99]
    v_add_u32 v244, 0xd000, v4
    v_add_u32 v245, 0xd000, v5
    v_mfma_f32_16x16x32_bf16 v[100:103], v[48:51], v[36:39], v[100:103]
    v_add_u32 v246, 0xd000, v6
    v_add_u32 v247, 0xd000, v7
    v_mfma_f32_16x16x32_bf16 v[104:107], v[48:51], v[40:43], v[104:107]
    v_add_u32 v248, 0xd000, v8
    v_add_u32 v250, 0xd000, v10
    v_mfma_f32_16x16x32_bf16 v[108:111], v[48:51], v[44:47], v[108:111]
    v_add_u32 v249, 0xd000, v9
    v_add_u32 v251, 0xd000, v11
    ds_read_b64_tr_b16 v[48:49], v244 offset:0
    ds_read_b64_tr_b16 v[50:51], v244 offset:1024
    v_mfma_f32_16x16x32_bf16 v[112:115], v[52:55], v[32:35], v[112:115]
    ds_read_b128 v[16:19], v248 offset:0
    v_mfma_f32_16x16x32_bf16 v[116:119], v[52:55], v[36:39], v[116:119]
    ds_read_b128 v[20:23], v248 offset:2048
    v_mfma_f32_16x16x32_bf16 v[120:123], v[52:55], v[40:43], v[120:123]
    ds_read_b128 v[24:27], v248 offset:4096
    v_mfma_f32_16x16x32_bf16 v[124:127], v[52:55], v[44:47], v[124:127]
    ds_read_b128 v[28:31], v248 offset:6144
    ds_read_b64_tr_b16 v[52:53], v245 offset:0
    ds_read_b64_tr_b16 v[54:55], v245 offset:1024
    v_mfma_f32_16x16x32_bf16 v[128:131], v[56:59], v[32:35], v[128:131]
    v_mfma_f32_16x16x32_bf16 v[132:135], v[56:59], v[36:39], v[132:135]
    v_mfma_f32_16x16x32_bf16 v[136:139], v[56:59], v[40:43], v[136:139]
    v_mfma_f32_16x16x32_bf16 v[140:143], v[56:59], v[44:47], v[140:143]
    ds_read_b64_tr_b16 v[56:57], v246 offset:0
    ds_read_b64_tr_b16 v[58:59], v246 offset:1024
    v_mfma_f32_16x16x32_bf16 v[144:147], v[60:63], v[32:35], v[144:147]
    v_mfma_f32_16x16x32_bf16 v[148:151], v[60:63], v[36:39], v[148:151]
    v_mfma_f32_16x16x32_bf16 v[152:155], v[60:63], v[40:43], v[152:155]
    v_mfma_f32_16x16x32_bf16 v[156:159], v[60:63], v[44:47], v[156:159]
    ds_read_b64_tr_b16 v[60:61], v247 offset:0
    ds_read_b64_tr_b16 v[62:63], v247 offset:1024
    v_mfma_f32_16x16x32_bf16 v[160:163], v[64:67], v[32:35], v[160:163]
    v_mfma_f32_16x16x32_bf16 v[164:167], v[64:67], v[36:39], v[164:167]
    v_mfma_f32_16x16x32_bf16 v[168:171], v[64:67], v[40:43], v[168:171]
    v_mfma_f32_16x16x32_bf16 v[172:175], v[64:67], v[44:47], v[172:175]
    ds_read_b64_tr_b16 v[64:65], v244 offset:16384
    ds_read_b64_tr_b16 v[66:67], v244 offset:17408
    v_mfma_f32_16x16x32_bf16 v[176:179], v[68:71], v[32:35], v[176:179]
    v_mfma_f32_16x16x32_bf16 v[180:183], v[68:71], v[36:39], v[180:183]
    v_mfma_f32_16x16x32_bf16 v[184:187], v[68:71], v[40:43], v[184:187]
    v_mfma_f32_16x16x32_bf16 v[188:191], v[68:71], v[44:47], v[188:191]
    ds_read_b64_tr_b16 v[68:69], v245 offset:16384
    ds_read_b64_tr_b16 v[70:71], v245 offset:17408
    v_mfma_f32_16x16x32_bf16 v[192:195], v[72:75], v[32:35], v[192:195]
    v_mfma_f32_16x16x32_bf16 v[196:199], v[72:75], v[36:39], v[196:199]
    v_mfma_f32_16x16x32_bf16 v[200:203], v[72:75], v[40:43], v[200:203]
    v_mfma_f32_16x16x32_bf16 v[204:207], v[72:75], v[44:47], v[204:207]
    ds_read_b64_tr_b16 v[72:73], v246 offset:16384
    ds_read_b64_tr_b16 v[74:75], v246 offset:17408
    v_mfma_f32_16x16x32_bf16 v[208:211], v[76:79], v[32:35], v[208:211]
    v_mfma_f32_16x16x32_bf16 v[212:215], v[76:79], v[36:39], v[212:215]
    v_mfma_f32_16x16x32_bf16 v[216:219], v[76:79], v[40:43], v[216:219]
    v_mfma_f32_16x16x32_bf16 v[220:223], v[76:79], v[44:47], v[220:223]
    ds_read_b64_tr_b16 v[76:77], v247 offset:16384
    ds_read_b64_tr_b16 v[78:79], v247 offset:17408
    v_mfma_f32_16x16x32_bf16 v[224:227], v[32:35], v[80:83], v[224:227]
    v_mfma_f32_16x16x32_bf16 v[228:231], v[36:39], v[80:83], v[228:231]
    v_mfma_f32_16x16x32_bf16 v[232:235], v[40:43], v[80:83], v[232:235]
    v_mfma_f32_16x16x32_bf16 v[236:239], v[44:47], v[80:83], v[236:239]
    ds_read_b128 v[80:83], v250 offset:0
    s_waitcnt lgkmcnt(15)
    v_mfma_f32_16x16x32_bf16 v[96:99], v[48:51], v[16:19], v[96:99]
    v_mfma_f32_16x16x32_bf16 v[100:103], v[48:51], v[20:23], v[100:103]
    v_mfma_f32_16x16x32_bf16 v[104:107], v[48:51], v[24:27], v[104:107]
    v_mfma_f32_16x16x32_bf16 v[108:111], v[48:51], v[28:31], v[108:111]
    ds_read_b64_tr_b16 v[48:49], v244 offset:8192
    ds_read_b64_tr_b16 v[50:51], v244 offset:9216
    s_waitcnt lgkmcnt(15)
    v_mfma_f32_16x16x32_bf16 v[112:115], v[52:55], v[16:19], v[112:115]
    ds_read_b128 v[32:35], v249 offset:0
    v_mfma_f32_16x16x32_bf16 v[116:119], v[52:55], v[20:23], v[116:119]
    ds_read_b128 v[36:39], v249 offset:2048
    v_mfma_f32_16x16x32_bf16 v[120:123], v[52:55], v[24:27], v[120:123]
    ds_read_b128 v[40:43], v249 offset:4096
    v_mfma_f32_16x16x32_bf16 v[124:127], v[52:55], v[28:31], v[124:127]
    ds_read_b128 v[44:47], v249 offset:6144
    ds_read_b64_tr_b16 v[52:53], v245 offset:8192
    ds_read_b64_tr_b16 v[54:55], v245 offset:9216
    s_waitcnt lgkmcnt(15)
    v_mfma_f32_16x16x32_bf16 v[128:131], v[56:59], v[16:19], v[128:131]
    v_mfma_f32_16x16x32_bf16 v[132:135], v[56:59], v[20:23], v[132:135]
    v_mfma_f32_16x16x32_bf16 v[136:139], v[56:59], v[24:27], v[136:139]
    v_mfma_f32_16x16x32_bf16 v[140:143], v[56:59], v[28:31], v[140:143]
    ds_read_b64_tr_b16 v[56:57], v246 offset:8192
    ds_read_b64_tr_b16 v[58:59], v246 offset:9216
    s_waitcnt lgkmcnt(15)
    v_mfma_f32_16x16x32_bf16 v[144:147], v[60:63], v[16:19], v[144:147]
    v_mfma_f32_16x16x32_bf16 v[148:151], v[60:63], v[20:23], v[148:151]
    v_mfma_f32_16x16x32_bf16 v[152:155], v[60:63], v[24:27], v[152:155]
    v_mfma_f32_16x16x32_bf16 v[156:159], v[60:63], v[28:31], v[156:159]
    ds_read_b64_tr_b16 v[60:61], v247 offset:8192
    ds_read_b64_tr_b16 v[62:63], v247 offset:9216
    s_waitcnt lgkmcnt(15)
    v_mfma_f32_16x16x32_bf16 v[160:163], v[64:67], v[16:19], v[160:163]
    v_mfma_f32_16x16x32_bf16 v[164:167], v[64:67], v[20:23], v[164:167]
    v_mfma_f32_16x16x32_bf16 v[168:171], v[64:67], v[24:27], v[168:171]
    v_mfma_f32_16x16x32_bf16 v[172:175], v[64:67], v[28:31], v[172:175]
    ds_read_b64_tr_b16 v[64:65], v244 offset:24576
    ds_read_b64_tr_b16 v[66:67], v244 offset:25600
    s_waitcnt lgkmcnt(15)
    v_mfma_f32_16x16x32_bf16 v[176:179], v[68:71], v[16:19], v[176:179]
    v_mfma_f32_16x16x32_bf16 v[180:183], v[68:71], v[20:23], v[180:183]
    v_mfma_f32_16x16x32_bf16 v[184:187], v[68:71], v[24:27], v[184:187]
    v_mfma_f32_16x16x32_bf16 v[188:191], v[68:71], v[28:31], v[188:191]
    ds_read_b64_tr_b16 v[68:69], v245 offset:24576
    ds_read_b64_tr_b16 v[70:71], v245 offset:25600
    s_waitcnt lgkmcnt(15)
    v_mfma_f32_16x16x32_bf16 v[192:195], v[72:75], v[16:19], v[192:195]
    v_mfma_f32_16x16x32_bf16 v[196:199], v[72:75], v[20:23], v[196:199]
    v_mfma_f32_16x16x32_bf16 v[200:203], v[72:75], v[24:27], v[200:203]
    v_mfma_f32_16x16x32_bf16 v[204:207], v[72:75], v[28:31], v[204:207]
    ds_read_b64_tr_b16 v[72:73], v246 offset:24576
    ds_read_b64_tr_b16 v[74:75], v246 offset:25600
    s_waitcnt lgkmcnt(15)
    v_mfma_f32_16x16x32_bf16 v[208:211], v[76:79], v[16:19], v[208:211]
    v_mfma_f32_16x16x32_bf16 v[212:215], v[76:79], v[20:23], v[212:215]
    v_mfma_f32_16x16x32_bf16 v[216:219], v[76:79], v[24:27], v[216:219]
    v_mfma_f32_16x16x32_bf16 v[220:223], v[76:79], v[28:31], v[220:223]
    ds_read_b64_tr_b16 v[76:77], v247 offset:24576
    ds_read_b64_tr_b16 v[78:79], v247 offset:25600
    s_waitcnt lgkmcnt(15)
    v_mfma_f32_16x16x32_bf16 v[224:227], v[16:19], v[80:83], v[224:227]
    v_mfma_f32_16x16x32_bf16 v[228:231], v[20:23], v[80:83], v[228:231]
    v_mfma_f32_16x16x32_bf16 v[232:235], v[24:27], v[80:83], v[232:235]
    v_mfma_f32_16x16x32_bf16 v[236:239], v[28:31], v[80:83], v[236:239]
    ds_read_b128 v[80:83], v251 offset:0
    s_waitcnt lgkmcnt(0)
    s_barrier
    v_mfma_f32_16x16x32_bf16 v[96:99], v[48:51], v[32:35], v[96:99]
    v_add_u32 v244, 0x1a000, v4
    v_add_u32 v245, 0x1a000, v5
    v_mfma_f32_16x16x32_bf16 v[100:103], v[48:51], v[36:39], v[100:103]
    v_add_u32 v246, 0x1a000, v6
    v_add_u32 v247, 0x1a000, v7
    v_mfma_f32_16x16x32_bf16 v[104:107], v[48:51], v[40:43], v[104:107]
    v_add_u32 v248, 0x1a000, v8
    v_add_u32 v250, 0x1a000, v10
    v_mfma_f32_16x16x32_bf16 v[108:111], v[48:51], v[44:47], v[108:111]
    v_add_u32 v249, 0x1a000, v9
    v_add_u32 v251, 0x1a000, v11
    ds_read_b64_tr_b16 v[48:49], v244 offset:0
    ds_read_b64_tr_b16 v[50:51], v244 offset:1024
    v_mfma_f32_16x16x32_bf16 v[112:115], v[52:55], v[32:35], v[112:115]
    ds_read_b128 v[16:19], v248 offset:0
    v_mfma_f32_16x16x32_bf16 v[116:119], v[52:55], v[36:39], v[116:119]
    ds_read_b128 v[20:23], v248 offset:2048
    v_mfma_f32_16x16x32_bf16 v[120:123], v[52:55], v[40:43], v[120:123]
    ds_read_b128 v[24:27], v248 offset:4096
    v_mfma_f32_16x16x32_bf16 v[124:127], v[52:55], v[44:47], v[124:127]
    ds_read_b128 v[28:31], v248 offset:6144
    ds_read_b64_tr_b16 v[52:53], v245 offset:0
    ds_read_b64_tr_b16 v[54:55], v245 offset:1024
    v_mfma_f32_16x16x32_bf16 v[128:131], v[56:59], v[32:35], v[128:131]
    v_mfma_f32_16x16x32_bf16 v[132:135], v[56:59], v[36:39], v[132:135]
    v_mfma_f32_16x16x32_bf16 v[136:139], v[56:59], v[40:43], v[136:139]
    v_mfma_f32_16x16x32_bf16 v[140:143], v[56:59], v[44:47], v[140:143]
    ds_read_b64_tr_b16 v[56:57], v246 offset:0
    ds_read_b64_tr_b16 v[58:59], v246 offset:1024
    v_mfma_f32_16x16x32_bf16 v[144:147], v[60:63], v[32:35], v[144:147]
    v_mfma_f32_16x16x32_bf16 v[148:151], v[60:63], v[36:39], v[148:151]
    v_mfma_f32_16x16x32_bf16 v[152:155], v[60:63], v[40:43], v[152:155]
    v_mfma_f32_16x16x32_bf16 v[156:159], v[60:63], v[44:47], v[156:159]
    ds_read_b64_tr_b16 v[60:61], v247 offset:0
    ds_read_b64_tr_b16 v[62:63], v247 offset:1024
    v_mfma_f32_16x16x32_bf16 v[160:163], v[64:67], v[32:35], v[160:163]
    v_mfma_f32_16x16x32_bf16 v[164:167], v[64:67], v[36:39], v[164:167]
    v_mfma_f32_16x16x32_bf16 v[168:171], v[64:67], v[40:43], v[168:171]
    v_mfma_f32_16x16x32_bf16 v[172:175], v[64:67], v[44:47], v[172:175]
    ds_read_b64_tr_b16 v[64:65], v244 offset:16384
    ds_read_b64_tr_b16 v[66:67], v244 offset:17408
    v_mfma_f32_16x16x32_bf16 v[176:179], v[68:71], v[32:35], v[176:179]
    v_mfma_f32_16x16x32_bf16 v[180:183], v[68:71], v[36:39], v[180:183]
    v_mfma_f32_16x16x32_bf16 v[184:187], v[68:71], v[40:43], v[184:187]
    v_mfma_f32_16x16x32_bf16 v[188:191], v[68:71], v[44:47], v[188:191]
    ds_read_b64_tr_b16 v[68:69], v245 offset:16384
    ds_read_b64_tr_b16 v[70:71], v245 offset:17408
    v_mfma_f32_16x16x32_bf16 v[192:195], v[72:75], v[32:35], v[192:195]
    v_mfma_f32_16x16x32_bf16 v[196:199], v[72:75], v[36:39], v[196:199]
    v_mfma_f32_16x16x32_bf16 v[200:203], v[72:75], v[40:43], v[200:203]
    v_mfma_f32_16x16x32_bf16 v[204:207], v[72:75], v[44:47], v[204:207]
    ds_read_b64_tr_b16 v[72:73], v246 offset:16384
    ds_read_b64_tr_b16 v[74:75], v246 offset:17408
    v_mfma_f32_16x16x32_bf16 v[208:211], v[76:79], v[32:35], v[208:211]
    v_mfma_f32_16x16x32_bf16 v[212:215], v[76:79], v[36:39], v[212:215]
    v_mfma_f32_16x16x32_bf16 v[216:219], v[76:79], v[40:43], v[216:219]
    v_mfma_f32_16x16x32_bf16 v[220:223], v[76:79], v[44:47], v[220:223]
    ds_read_b64_tr_b16 v[76:77], v247 offset:16384
    ds_read_b64_tr_b16 v[78:79], v247 offset:17408
    v_mfma_f32_16x16x32_bf16 v[224:227], v[32:35], v[80:83], v[224:227]
    v_mfma_f32_16x16x32_bf16 v[228:231], v[36:39], v[80:83], v[228:231]
    v_mfma_f32_16x16x32_bf16 v[232:235], v[40:43], v[80:83], v[232:235]
    v_mfma_f32_16x16x32_bf16 v[236:239], v[44:47], v[80:83], v[236:239]
    ds_read_b128 v[80:83], v250 offset:0
    s_waitcnt lgkmcnt(15)
    v_mfma_f32_16x16x32_bf16 v[96:99], v[48:51], v[16:19], v[96:99]
    v_mfma_f32_16x16x32_bf16 v[100:103], v[48:51], v[20:23], v[100:103]
    v_mfma_f32_16x16x32_bf16 v[104:107], v[48:51], v[24:27], v[104:107]
    v_mfma_f32_16x16x32_bf16 v[108:111], v[48:51], v[28:31], v[108:111]
    ds_read_b64_tr_b16 v[48:49], v244 offset:8192
    ds_read_b64_tr_b16 v[50:51], v244 offset:9216
    s_waitcnt lgkmcnt(15)
    v_mfma_f32_16x16x32_bf16 v[112:115], v[52:55], v[16:19], v[112:115]
    ds_read_b128 v[32:35], v249 offset:0
    v_mfma_f32_16x16x32_bf16 v[116:119], v[52:55], v[20:23], v[116:119]
    ds_read_b128 v[36:39], v249 offset:2048
    v_mfma_f32_16x16x32_bf16 v[120:123], v[52:55], v[24:27], v[120:123]
    ds_read_b128 v[40:43], v249 offset:4096
    v_mfma_f32_16x16x32_bf16 v[124:127], v[52:55], v[28:31], v[124:127]
    ds_read_b128 v[44:47], v249 offset:6144
    ds_read_b64_tr_b16 v[52:53], v245 offset:8192
    ds_read_b64_tr_b16 v[54:55], v245 offset:9216
    s_waitcnt lgkmcnt(15)
    v_mfma_f32_16x16x32_bf16 v[128:131], v[56:59], v[16:19], v[128:131]
    v_mfma_f32_16x16x32_bf16 v[132:135], v[56:59], v[20:23], v[132:135]
    v_mfma_f32_16x16x32_bf16 v[136:139], v[56:59], v[24:27], v[136:139]
    v_mfma_f32_16x16x32_bf16 v[140:143], v[56:59], v[28:31], v[140:143]
    ds_read_b64_tr_b16 v[56:57], v246 offset:8192
    ds_read_b64_tr_b16 v[58:59], v246 offset:9216
    s_waitcnt lgkmcnt(15)
    v_mfma_f32_16x16x32_bf16 v[144:147], v[60:63], v[16:19], v[144:147]
    v_mfma_f32_16x16x32_bf16 v[148:151], v[60:63], v[20:23], v[148:151]
    v_mfma_f32_16x16x32_bf16 v[152:155], v[60:63], v[24:27], v[152:155]
    v_mfma_f32_16x16x32_bf16 v[156:159], v[60:63], v[28:31], v[156:159]
    ds_read_b64_tr_b16 v[60:61], v247 offset:8192
    ds_read_b64_tr_b16 v[62:63], v247 offset:9216
    s_waitcnt lgkmcnt(15)
    v_mfma_f32_16x16x32_bf16 v[160:163], v[64:67], v[16:19], v[160:163]
    v_mfma_f32_16x16x32_bf16 v[164:167], v[64:67], v[20:23], v[164:167]
    v_mfma_f32_16x16x32_bf16 v[168:171], v[64:67], v[24:27], v[168:171]
    v_mfma_f32_16x16x32_bf16 v[172:175], v[64:67], v[28:31], v[172:175]
    ds_read_b64_tr_b16 v[64:65], v244 offset:24576
    ds_read_b64_tr_b16 v[66:67], v244 offset:25600
    s_waitcnt lgkmcnt(15)
    v_mfma_f32_16x16x32_bf16 v[176:179], v[68:71], v[16:19], v[176:179]
    v_mfma_f32_16x16x32_bf16 v[180:183], v[68:71], v[20:23], v[180:183]
    v_mfma_f32_16x16x32_bf16 v[184:187], v[68:71], v[24:27], v[184:187]
    v_mfma_f32_16x16x32_bf16 v[188:191], v[68:71], v[28:31], v[188:191]
    ds_read_b64_tr_b16 v[68:69], v245 offset:24576
    ds_read_b64_tr_b16 v[70:71], v245 offset:25600
    s_waitcnt lgkmcnt(15)
    v_mfma_f32_16x16x32_bf16 v[192:195], v[72:75], v[16:19], v[192:195]
    v_mfma_f32_16x16x32_bf16 v[196:199], v[72:75], v[20:23], v[196:199]
    v_mfma_f32_16x16x32_bf16 v[200:203], v[72:75], v[24:27], v[200:203]
    v_mfma_f32_16x16x32_bf16 v[204:207], v[72:75], v[28:31], v[204:207]
    ds_read_b64_tr_b16 v[72:73], v246 offset:24576
    ds_read_b64_tr_b16 v[74:75], v246 offset:25600
    s_waitcnt lgkmcnt(15)
    v_mfma_f32_16x16x32_bf16 v[208:211], v[76:79], v[16:19], v[208:211]
    v_mfma_f32_16x16x32_bf16 v[212:215], v[76:79], v[20:23], v[212:215]
    v_mfma_f32_16x16x32_bf16 v[216:219], v[76:79], v[24:27], v[216:219]
    v_mfma_f32_16x16x32_bf16 v[220:223], v[76:79], v[28:31], v[220:223]
    ds_read_b64_tr_b16 v[76:77], v247 offset:24576
    ds_read_b64_tr_b16 v[78:79], v247 offset:25600
    s_waitcnt lgkmcnt(15)
    v_mfma_f32_16x16x32_bf16 v[224:227], v[16:19], v[80:83], v[224:227]
    v_mfma_f32_16x16x32_bf16 v[228:231], v[20:23], v[80:83], v[228:231]
    v_mfma_f32_16x16x32_bf16 v[232:235], v[24:27], v[80:83], v[232:235]
    v_mfma_f32_16x16x32_bf16 v[236:239], v[28:31], v[80:83], v[236:239]
    ds_read_b128 v[80:83], v251 offset:0
    s_waitcnt lgkmcnt(0)
    s_barrier
    v_mfma_f32_16x16x32_bf16 v[96:99], v[48:51], v[32:35], v[96:99]
    v_add_u32 v244, 0x0, v4
    v_add_u32 v245, 0x0, v5
    v_mfma_f32_16x16x32_bf16 v[100:103], v[48:51], v[36:39], v[100:103]
    v_add_u32 v246, 0x0, v6
    v_add_u32 v247, 0x0, v7
    v_mfma_f32_16x16x32_bf16 v[104:107], v[48:51], v[40:43], v[104:107]
    v_add_u32 v248, 0x0, v8
    v_add_u32 v250, 0x0, v10
    v_mfma_f32_16x16x32_bf16 v[108:111], v[48:51], v[44:47], v[108:111]
    v_add_u32 v249, 0x0, v9
    v_add_u32 v251, 0x0, v11
    ds_read_b64_tr_b16 v[48:49], v244 offset:0
    ds_read_b64_tr_b16 v[50:51], v244 offset:1024
    v_mfma_f32_16x16x32_bf16 v[112:115], v[52:55], v[32:35], v[112:115]
    ds_read_b128 v[16:19], v248 offset:0
    v_mfma_f32_16x16x32_bf16 v[116:119], v[52:55], v[36:39], v[116:119]
    ds_read_b128 v[20:23], v248 offset:2048
    v_mfma_f32_16x16x32_bf16 v[120:123], v[52:55], v[40:43], v[120:123]
    ds_read_b128 v[24:27], v248 offset:4096
    v_mfma_f32_16x16x32_bf16 v[124:127], v[52:55], v[44:47], v[124:127]
    ds_read_b128 v[28:31], v248 offset:6144
    ds_read_b64_tr_b16 v[52:53], v245 offset:0
    ds_read_b64_tr_b16 v[54:55], v245 offset:1024
    v_mfma_f32_16x16x32_bf16 v[128:131], v[56:59], v[32:35], v[128:131]
    v_mfma_f32_16x16x32_bf16 v[132:135], v[56:59], v[36:39], v[132:135]
    v_mfma_f32_16x16x32_bf16 v[136:139], v[56:59], v[40:43], v[136:139]
    v_mfma_f32_16x16x32_bf16 v[140:143], v[56:59], v[44:47], v[140:143]
    ds_read_b64_tr_b16 v[56:57], v246 offset:0
    ds_read_b64_tr_b16 v[58:59], v246 offset:1024
    v_mfma_f32_16x16x32_bf16 v[144:147], v[60:63], v[32:35], v[144:147]
    v_mfma_f32_16x16x32_bf16 v[148:151], v[60:63], v[36:39], v[148:151]
    v_mfma_f32_16x16x32_bf16 v[152:155], v[60:63], v[40:43], v[152:155]
    v_mfma_f32_16x16x32_bf16 v[156:159], v[60:63], v[44:47], v[156:159]
    ds_read_b64_tr_b16 v[60:61], v247 offset:0
    ds_read_b64_tr_b16 v[62:63], v247 offset:1024
    v_mfma_f32_16x16x32_bf16 v[160:163], v[64:67], v[32:35], v[160:163]
    v_mfma_f32_16x16x32_bf16 v[164:167], v[64:67], v[36:39], v[164:167]
    v_mfma_f32_16x16x32_bf16 v[168:171], v[64:67], v[40:43], v[168:171]
    v_mfma_f32_16x16x32_bf16 v[172:175], v[64:67], v[44:47], v[172:175]
    ds_read_b64_tr_b16 v[64:65], v244 offset:16384
    ds_read_b64_tr_b16 v[66:67], v244 offset:17408
    v_mfma_f32_16x16x32_bf16 v[176:179], v[68:71], v[32:35], v[176:179]
    v_mfma_f32_16x16x32_bf16 v[180:183], v[68:71], v[36:39], v[180:183]
    v_mfma_f32_16x16x32_bf16 v[184:187], v[68:71], v[40:43], v[184:187]
    v_mfma_f32_16x16x32_bf16 v[188:191], v[68:71], v[44:47], v[188:191]
    ds_read_b64_tr_b16 v[68:69], v245 offset:16384
    ds_read_b64_tr_b16 v[70:71], v245 offset:17408
    v_mfma_f32_16x16x32_bf16 v[192:195], v[72:75], v[32:35], v[192:195]
    v_mfma_f32_16x16x32_bf16 v[196:199], v[72:75], v[36:39], v[196:199]
    v_mfma_f32_16x16x32_bf16 v[200:203], v[72:75], v[40:43], v[200:203]
    v_mfma_f32_16x16x32_bf16 v[204:207], v[72:75], v[44:47], v[204:207]
    ds_read_b64_tr_b16 v[72:73], v246 offset:16384
    ds_read_b64_tr_b16 v[74:75], v246 offset:17408
    v_mfma_f32_16x16x32_bf16 v[208:211], v[76:79], v[32:35], v[208:211]
    v_mfma_f32_16x16x32_bf16 v[212:215], v[76:79], v[36:39], v[212:215]
    v_mfma_f32_16x16x32_bf16 v[216:219], v[76:79], v[40:43], v[216:219]
    v_mfma_f32_16x16x32_bf16 v[220:223], v[76:79], v[44:47], v[220:223]
    ds_read_b64_tr_b16 v[76:77], v247 offset:16384
    ds_read_b64_tr_b16 v[78:79], v247 offset:17408
    v_mfma_f32_16x16x32_bf16 v[224:227], v[32:35], v[80:83], v[224:227]
    v_mfma_f32_16x16x32_bf16 v[228:231], v[36:39], v[80:83], v[228:231]
    v_mfma_f32_16x16x32_bf16 v[232:235], v[40:43], v[80:83], v[232:235]
    v_mfma_f32_16x16x32_bf16 v[236:239], v[44:47], v[80:83], v[236:239]
    ds_read_b128 v[80:83], v250 offset:0
    s_waitcnt lgkmcnt(15)
    v_mfma_f32_16x16x32_bf16 v[96:99], v[48:51], v[16:19], v[96:99]
    v_mfma_f32_16x16x32_bf16 v[100:103], v[48:51], v[20:23], v[100:103]
    v_mfma_f32_16x16x32_bf16 v[104:107], v[48:51], v[24:27], v[104:107]
    v_mfma_f32_16x16x32_bf16 v[108:111], v[48:51], v[28:31], v[108:111]
    ds_read_b64_tr_b16 v[48:49], v244 offset:8192
    ds_read_b64_tr_b16 v[50:51], v244 offset:9216
    s_waitcnt lgkmcnt(15)
    v_mfma_f32_16x16x32_bf16 v[112:115], v[52:55], v[16:19], v[112:115]
    ds_read_b128 v[32:35], v249 offset:0
    v_mfma_f32_16x16x32_bf16 v[116:119], v[52:55], v[20:23], v[116:119]
    ds_read_b128 v[36:39], v249 offset:2048
    v_mfma_f32_16x16x32_bf16 v[120:123], v[52:55], v[24:27], v[120:123]
    ds_read_b128 v[40:43], v249 offset:4096
    v_mfma_f32_16x16x32_bf16 v[124:127], v[52:55], v[28:31], v[124:127]
    ds_read_b128 v[44:47], v249 offset:6144
    ds_read_b64_tr_b16 v[52:53], v245 offset:8192
    ds_read_b64_tr_b16 v[54:55], v245 offset:9216
    s_waitcnt lgkmcnt(15)
    v_mfma_f32_16x16x32_bf16 v[128:131], v[56:59], v[16:19], v[128:131]
    v_mfma_f32_16x16x32_bf16 v[132:135], v[56:59], v[20:23], v[132:135]
    v_mfma_f32_16x16x32_bf16 v[136:139], v[56:59], v[24:27], v[136:139]
    v_mfma_f32_16x16x32_bf16 v[140:143], v[56:59], v[28:31], v[140:143]
    ds_read_b64_tr_b16 v[56:57], v246 offset:8192
    ds_read_b64_tr_b16 v[58:59], v246 offset:9216
    s_waitcnt lgkmcnt(15)
    v_mfma_f32_16x16x32_bf16 v[144:147], v[60:63], v[16:19], v[144:147]
    v_mfma_f32_16x16x32_bf16 v[148:151], v[60:63], v[20:23], v[148:151]
    v_mfma_f32_16x16x32_bf16 v[152:155], v[60:63], v[24:27], v[152:155]
    v_mfma_f32_16x16x32_bf16 v[156:159], v[60:63], v[28:31], v[156:159]
    ds_read_b64_tr_b16 v[60:61], v247 offset:8192
    ds_read_b64_tr_b16 v[62:63], v247 offset:9216
    s_waitcnt lgkmcnt(15)
    v_mfma_f32_16x16x32_bf16 v[160:163], v[64:67], v[16:19], v[160:163]
    v_mfma_f32_16x16x32_bf16 v[164:167], v[64:67], v[20:23], v[164:167]
    v_mfma_f32_16x16x32_bf16 v[168:171], v[64:67], v[24:27], v[168:171]
    v_mfma_f32_16x16x32_bf16 v[172:175], v[64:67], v[28:31], v[172:175]
    ds_read_b64_tr_b16 v[64:65], v244 offset:24576
    ds_read_b64_tr_b16 v[66:67], v244 offset:25600
    s_waitcnt lgkmcnt(15)
    v_mfma_f32_16x16x32_bf16 v[176:179], v[68:71], v[16:19], v[176:179]
    v_mfma_f32_16x16x32_bf16 v[180:183], v[68:71], v[20:23], v[180:183]
    v_mfma_f32_16x16x32_bf16 v[184:187], v[68:71], v[24:27], v[184:187]
    v_mfma_f32_16x16x32_bf16 v[188:191], v[68:71], v[28:31], v[188:191]
    ds_read_b64_tr_b16 v[68:69], v245 offset:24576
    ds_read_b64_tr_b16 v[70:71], v245 offset:25600
    s_waitcnt lgkmcnt(15)
    v_mfma_f32_16x16x32_bf16 v[192:195], v[72:75], v[16:19], v[192:195]
    v_mfma_f32_16x16x32_bf16 v[196:199], v[72:75], v[20:23], v[196:199]
    v_mfma_f32_16x16x32_bf16 v[200:203], v[72:75], v[24:27], v[200:203]
    v_mfma_f32_16x16x32_bf16 v[204:207], v[72:75], v[28:31], v[204:207]
    ds_read_b64_tr_b16 v[72:73], v246 offset:24576
    ds_read_b64_tr_b16 v[74:75], v246 offset:25600
    s_waitcnt lgkmcnt(15)
    v_mfma_f32_16x16x32_bf16 v[208:211], v[76:79], v[16:19], v[208:211]
    v_mfma_f32_16x16x32_bf16 v[212:215], v[76:79], v[20:23], v[212:215]
    v_mfma_f32_16x16x32_bf16 v[216:219], v[76:79], v[24:27], v[216:219]
    v_mfma_f32_16x16x32_bf16 v[220:223], v[76:79], v[28:31], v[220:223]
    ds_read_b64_tr_b16 v[76:77], v247 offset:24576
    ds_read_b64_tr_b16 v[78:79], v247 offset:25600
    s_waitcnt lgkmcnt(15)
    v_mfma_f32_16x16x32_bf16 v[224:227], v[16:19], v[80:83], v[224:227]
    v_mfma_f32_16x16x32_bf16 v[228:231], v[20:23], v[80:83], v[228:231]
    v_mfma_f32_16x16x32_bf16 v[232:235], v[24:27], v[80:83], v[232:235]
    v_mfma_f32_16x16x32_bf16 v[236:239], v[28:31], v[80:83], v[236:239]
    ds_read_b128 v[80:83], v251 offset:0
    s_waitcnt lgkmcnt(0)
    s_barrier
    v_mfma_f32_16x16x32_bf16 v[96:99], v[48:51], v[32:35], v[96:99]
    v_add_u32 v244, 0xd000, v4
    v_add_u32 v245, 0xd000, v5
    v_mfma_f32_16x16x32_bf16 v[100:103], v[48:51], v[36:39], v[100:103]
    v_add_u32 v246, 0xd000, v6
    v_add_u32 v247, 0xd000, v7
    v_mfma_f32_16x16x32_bf16 v[104:107], v[48:51], v[40:43], v[104:107]
    v_add_u32 v248, 0xd000, v8
    v_add_u32 v250, 0xd000, v10
    v_mfma_f32_16x16x32_bf16 v[108:111], v[48:51], v[44:47], v[108:111]
    v_add_u32 v249, 0xd000, v9
    v_add_u32 v251, 0xd000, v11
    ds_read_b64_tr_b16 v[48:49], v244 offset:0
    ds_read_b64_tr_b16 v[50:51], v244 offset:1024
    v_mfma_f32_16x16x32_bf16 v[112:115], v[52:55], v[32:35], v[112:115]
    ds_read_b128 v[16:19], v248 offset:0
    v_mfma_f32_16x16x32_bf16 v[116:119], v[52:55], v[36:39], v[116:119]
    ds_read_b128 v[20:23], v248 offset:2048
    v_mfma_f32_16x16x32_bf16 v[120:123], v[52:55], v[40:43], v[120:123]
    ds_read_b128 v[24:27], v248 offset:4096
    v_mfma_f32_16x16x32_bf16 v[124:127], v[52:55], v[44:47], v[124:127]
    ds_read_b128 v[28:31], v248 offset:6144
    ds_read_b64_tr_b16 v[52:53], v245 offset:0
    ds_read_b64_tr_b16 v[54:55], v245 offset:1024
    v_mfma_f32_16x16x32_bf16 v[128:131], v[56:59], v[32:35], v[128:131]
    v_mfma_f32_16x16x32_bf16 v[132:135], v[56:59], v[36:39], v[132:135]
    v_mfma_f32_16x16x32_bf16 v[136:139], v[56:59], v[40:43], v[136:139]
    v_mfma_f32_16x16x32_bf16 v[140:143], v[56:59], v[44:47], v[140:143]
    ds_read_b64_tr_b16 v[56:57], v246 offset:0
    ds_read_b64_tr_b16 v[58:59], v246 offset:1024
    v_mfma_f32_16x16x32_bf16 v[144:147], v[60:63], v[32:35], v[144:147]
    v_mfma_f32_16x16x32_bf16 v[148:151], v[60:63], v[36:39], v[148:151]
    v_mfma_f32_16x16x32_bf16 v[152:155], v[60:63], v[40:43], v[152:155]
    v_mfma_f32_16x16x32_bf16 v[156:159], v[60:63], v[44:47], v[156:159]
    ds_read_b64_tr_b16 v[60:61], v247 offset:0
    ds_read_b64_tr_b16 v[62:63], v247 offset:1024
    v_mfma_f32_16x16x32_bf16 v[160:163], v[64:67], v[32:35], v[160:163]
    v_mfma_f32_16x16x32_bf16 v[164:167], v[64:67], v[36:39], v[164:167]
    v_mfma_f32_16x16x32_bf16 v[168:171], v[64:67], v[40:43], v[168:171]
    v_mfma_f32_16x16x32_bf16 v[172:175], v[64:67], v[44:47], v[172:175]
    ds_read_b64_tr_b16 v[64:65], v244 offset:16384
    ds_read_b64_tr_b16 v[66:67], v244 offset:17408
    v_mfma_f32_16x16x32_bf16 v[176:179], v[68:71], v[32:35], v[176:179]
    v_mfma_f32_16x16x32_bf16 v[180:183], v[68:71], v[36:39], v[180:183]
    v_mfma_f32_16x16x32_bf16 v[184:187], v[68:71], v[40:43], v[184:187]
    v_mfma_f32_16x16x32_bf16 v[188:191], v[68:71], v[44:47], v[188:191]
    ds_read_b64_tr_b16 v[68:69], v245 offset:16384
    ds_read_b64_tr_b16 v[70:71], v245 offset:17408
    v_mfma_f32_16x16x32_bf16 v[192:195], v[72:75], v[32:35], v[192:195]
    v_mfma_f32_16x16x32_bf16 v[196:199], v[72:75], v[36:39], v[196:199]
    v_mfma_f32_16x16x32_bf16 v[200:203], v[72:75], v[40:43], v[200:203]
    v_mfma_f32_16x16x32_bf16 v[204:207], v[72:75], v[44:47], v[204:207]
    ds_read_b64_tr_b16 v[72:73], v246 offset:16384
    ds_read_b64_tr_b16 v[74:75], v246 offset:17408
    v_mfma_f32_16x16x32_bf16 v[208:211], v[76:79], v[32:35], v[208:211]
    v_mfma_f32_16x16x32_bf16 v[212:215], v[76:79], v[36:39], v[212:215]
    v_mfma_f32_16x16x32_bf16 v[216:219], v[76:79], v[40:43], v[216:219]
    v_mfma_f32_16x16x32_bf16 v[220:223], v[76:79], v[44:47], v[220:223]
    ds_read_b64_tr_b16 v[76:77], v247 offset:16384
    ds_read_b64_tr_b16 v[78:79], v247 offset:17408
    v_mfma_f32_16x16x32_bf16 v[224:227], v[32:35], v[80:83], v[224:227]
    v_mfma_f32_16x16x32_bf16 v[228:231], v[36:39], v[80:83], v[228:231]
    v_mfma_f32_16x16x32_bf16 v[232:235], v[40:43], v[80:83], v[232:235]
    v_mfma_f32_16x16x32_bf16 v[236:239], v[44:47], v[80:83], v[236:239]
    ds_read_b128 v[80:83], v250 offset:0
    s_waitcnt lgkmcnt(15)
    v_mfma_f32_16x16x32_bf16 v[96:99], v[48:51], v[16:19], v[96:99]
    v_mfma_f32_16x16x32_bf16 v[100:103], v[48:51], v[20:23], v[100:103]
    v_mfma_f32_16x16x32_bf16 v[104:107], v[48:51], v[24:27], v[104:107]
    v_mfma_f32_16x16x32_bf16 v[108:111], v[48:51], v[28:31], v[108:111]
    ds_read_b64_tr_b16 v[48:49], v244 offset:8192
    ds_read_b64_tr_b16 v[50:51], v244 offset:9216
    s_waitcnt lgkmcnt(15)
    v_mfma_f32_16x16x32_bf16 v[112:115], v[52:55], v[16:19], v[112:115]
    ds_read_b128 v[32:35], v249 offset:0
    v_mfma_f32_16x16x32_bf16 v[116:119], v[52:55], v[20:23], v[116:119]
    ds_read_b128 v[36:39], v249 offset:2048
    v_mfma_f32_16x16x32_bf16 v[120:123], v[52:55], v[24:27], v[120:123]
    ds_read_b128 v[40:43], v249 offset:4096
    v_mfma_f32_16x16x32_bf16 v[124:127], v[52:55], v[28:31], v[124:127]
    ds_read_b128 v[44:47], v249 offset:6144
    ds_read_b64_tr_b16 v[52:53], v245 offset:8192
    ds_read_b64_tr_b16 v[54:55], v245 offset:9216
    s_waitcnt lgkmcnt(15)
    v_mfma_f32_16x16x32_bf16 v[128:131], v[56:59], v[16:19], v[128:131]
    v_mfma_f32_16x16x32_bf16 v[132:135], v[56:59], v[20:23], v[132:135]
    v_mfma_f32_16x16x32_bf16 v[136:139], v[56:59], v[24:27], v[136:139]
    v_mfma_f32_16x16x32_bf16 v[140:143], v[56:59], v[28:31], v[140:143]
    ds_read_b64_tr_b16 v[56:57], v246 offset:8192
    ds_read_b64_tr_b16 v[58:59], v246 offset:9216
    s_waitcnt lgkmcnt(15)
    v_mfma_f32_16x16x32_bf16 v[144:147], v[60:63], v[16:19], v[144:147]
    v_mfma_f32_16x16x32_bf16 v[148:151], v[60:63], v[20:23], v[148:151]
    v_mfma_f32_16x16x32_bf16 v[152:155], v[60:63], v[24:27], v[152:155]
    v_mfma_f32_16x16x32_bf16 v[156:159], v[60:63], v[28:31], v[156:159]
    ds_read_b64_tr_b16 v[60:61], v247 offset:8192
    ds_read_b64_tr_b16 v[62:63], v247 offset:9216
    s_waitcnt lgkmcnt(15)
    v_mfma_f32_16x16x32_bf16 v[160:163], v[64:67], v[16:19], v[160:163]
    v_mfma_f32_16x16x32_bf16 v[164:167], v[64:67], v[20:23], v[164:167]
    v_mfma_f32_16x16x32_bf16 v[168:171], v[64:67], v[24:27], v[168:171]
    v_mfma_f32_16x16x32_bf16 v[172:175], v[64:67], v[28:31], v[172:175]
    ds_read_b64_tr_b16 v[64:65], v244 offset:24576
    ds_read_b64_tr_b16 v[66:67], v244 offset:25600
    s_waitcnt lgkmcnt(15)
    v_mfma_f32_16x16x32_bf16 v[176:179], v[68:71], v[16:19], v[176:179]
    v_mfma_f32_16x16x32_bf16 v[180:183], v[68:71], v[20:23], v[180:183]
    v_mfma_f32_16x16x32_bf16 v[184:187], v[68:71], v[24:27], v[184:187]
    v_mfma_f32_16x16x32_bf16 v[188:191], v[68:71], v[28:31], v[188:191]
    ds_read_b64_tr_b16 v[68:69], v245 offset:24576
    ds_read_b64_tr_b16 v[70:71], v245 offset:25600
    s_waitcnt lgkmcnt(15)
    v_mfma_f32_16x16x32_bf16 v[192:195], v[72:75], v[16:19], v[192:195]
    v_mfma_f32_16x16x32_bf16 v[196:199], v[72:75], v[20:23], v[196:199]
    v_mfma_f32_16x16x32_bf16 v[200:203], v[72:75], v[24:27], v[200:203]
    v_mfma_f32_16x16x32_bf16 v[204:207], v[72:75], v[28:31], v[204:207]
    ds_read_b64_tr_b16 v[72:73], v246 offset:24576
    ds_read_b64_tr_b16 v[74:75], v246 offset:25600
    s_waitcnt lgkmcnt(15)
    v_mfma_f32_16x16x32_bf16 v[208:211], v[76:79], v[16:19], v[208:211]
    v_mfma_f32_16x16x32_bf16 v[212:215], v[76:79], v[20:23], v[212:215]
    v_mfma_f32_16x16x32_bf16 v[216:219], v[76:79], v[24:27], v[216:219]
    v_mfma_f32_16x16x32_bf16 v[220:223], v[76:79], v[28:31], v[220:223]
    ds_read_b64_tr_b16 v[76:77], v247 offset:24576
    ds_read_b64_tr_b16 v[78:79], v247 offset:25600
    s_waitcnt lgkmcnt(15)
    v_mfma_f32_16x16x32_bf16 v[224:227], v[16:19], v[80:83], v[224:227]
    v_mfma_f32_16x16x32_bf16 v[228:231], v[20:23], v[80:83], v[228:231]
    v_mfma_f32_16x16x32_bf16 v[232:235], v[24:27], v[80:83], v[232:235]
    v_mfma_f32_16x16x32_bf16 v[236:239], v[28:31], v[80:83], v[236:239]
    ds_read_b128 v[80:83], v251 offset:0
    s_waitcnt lgkmcnt(15)
    v_mfma_f32_16x16x32_bf16 v[96:99], v[48:51], v[32:35], v[96:99]
    v_mfma_f32_16x16x32_bf16 v[100:103], v[48:51], v[36:39], v[100:103]
    v_mfma_f32_16x16x32_bf16 v[104:107], v[48:51], v[40:43], v[104:107]
    v_mfma_f32_16x16x32_bf16 v[108:111], v[48:51], v[44:47], v[108:111]
    s_waitcnt lgkmcnt(13)
    v_mfma_f32_16x16x32_bf16 v[112:115], v[52:55], v[32:35], v[112:115]
    v_mfma_f32_16x16x32_bf16 v[116:119], v[52:55], v[36:39], v[116:119]
    v_mfma_f32_16x16x32_bf16 v[120:123], v[52:55], v[40:43], v[120:123]
    v_mfma_f32_16x16x32_bf16 v[124:127], v[52:55], v[44:47], v[124:127]
    s_waitcnt lgkmcnt(11)
    v_mfma_f32_16x16x32_bf16 v[128:131], v[56:59], v[32:35], v[128:131]
    v_mfma_f32_16x16x32_bf16 v[132:135], v[56:59], v[36:39], v[132:135]
    v_mfma_f32_16x16x32_bf16 v[136:139], v[56:59], v[40:43], v[136:139]
    v_mfma_f32_16x16x32_bf16 v[140:143], v[56:59], v[44:47], v[140:143]
    s_waitcnt lgkmcnt(9)
    v_mfma_f32_16x16x32_bf16 v[144:147], v[60:63], v[32:35], v[144:147]
    v_mfma_f32_16x16x32_bf16 v[148:151], v[60:63], v[36:39], v[148:151]
    v_mfma_f32_16x16x32_bf16 v[152:155], v[60:63], v[40:43], v[152:155]
    v_mfma_f32_16x16x32_bf16 v[156:159], v[60:63], v[44:47], v[156:159]
    s_waitcnt lgkmcnt(7)
    v_mfma_f32_16x16x32_bf16 v[160:163], v[64:67], v[32:35], v[160:163]
    v_mfma_f32_16x16x32_bf16 v[164:167], v[64:67], v[36:39], v[164:167]
    v_mfma_f32_16x16x32_bf16 v[168:171], v[64:67], v[40:43], v[168:171]
    v_mfma_f32_16x16x32_bf16 v[172:175], v[64:67], v[44:47], v[172:175]
    s_waitcnt lgkmcnt(5)
    v_mfma_f32_16x16x32_bf16 v[176:179], v[68:71], v[32:35], v[176:179]
    v_mfma_f32_16x16x32_bf16 v[180:183], v[68:71], v[36:39], v[180:183]
    v_mfma_f32_16x16x32_bf16 v[184:187], v[68:71], v[40:43], v[184:187]
    v_mfma_f32_16x16x32_bf16 v[188:191], v[68:71], v[44:47], v[188:191]
    s_waitcnt lgkmcnt(3)
    v_mfma_f32_16x16x32_bf16 v[192:195], v[72:75], v[32:35], v[192:195]
    v_mfma_f32_16x16x32_bf16 v[196:199], v[72:75], v[36:39], v[196:199]
    v_mfma_f32_16x16x32_bf16 v[200:203], v[72:75], v[40:43], v[200:203]
    v_mfma_f32_16x16x32_bf16 v[204:207], v[72:75], v[44:47], v[204:207]
    s_waitcnt lgkmcnt(1)
    v_mfma_f32_16x16x32_bf16 v[208:211], v[76:79], v[32:35], v[208:211]
    v_mfma_f32_16x16x32_bf16 v[212:215], v[76:79], v[36:39], v[212:215]
    v_mfma_f32_16x16x32_bf16 v[216:219], v[76:79], v[40:43], v[216:219]
    v_mfma_f32_16x16x32_bf16 v[220:223], v[76:79], v[44:47], v[220:223]
    s_waitcnt lgkmcnt(0)
    v_mfma_f32_16x16x32_bf16 v[224:227], v[32:35], v[80:83], v[224:227]
    v_mfma_f32_16x16x32_bf16 v[228:231], v[36:39], v[80:83], v[228:231]
    v_mfma_f32_16x16x32_bf16 v[232:235], v[40:43], v[80:83], v[232:235]
    v_mfma_f32_16x16x32_bf16 v[236:239], v[44:47], v[80:83], v[236:239]
    s_nop 7
    s_barrier
    s_and_b32 s7, s3, 1
    s_lshl_b32 s7, s7, 6
    v_and_b32 v240, 15, v2
    v_add_u32 v241, s7, v240
    v_lshrrev_b32 v242, 4, v2
    v_and_b32 v248, 1, v242
    v_lshlrev_b32 v248, 3, v248
    v_lshrrev_b32 v242, 1, v242
    s_movk_i32 s6, 256
    v_mul_lo_u32 v244, v241, s6
    v_add_u32 v244, v244, v248
    v_and_b32 v245, 15, v241
    v_xor_b32 v245, v245, v242
    s_lshr_b32 s6, s3, 1
    s_mul_i32 s6, s6, 4096
    s_add_u32 s6, s6, 0x8000
    v_lshlrev_b32 v246, 8, v240
    v_add3_u32 v246, v246, v248, s6
    v_xor_b32 v247, v240, v242
    s_lshr_b32 s7, s7, 3
    v_xor_b32 v247, s7, v247
    s_mov_b32 s6, 0xbfb8aa3b
    s_lshr_b32 s101, s3, 1
    s_mul_i32 s101, s101, 8
    s_waitcnt lgkmcnt(0)
    v_mul_f32 v16, s6, v96
    v_mul_f32 v17, s6, v97
    v_mul_f32 v18, s6, v98
    v_mul_f32 v19, s6, v99
    v_mul_f32 v20, s6, v100
    v_mul_f32 v21, s6, v101
    v_mul_f32 v22, s6, v102
    v_mul_f32 v23, s6, v103
    v_mul_f32 v24, s6, v104
    v_mul_f32 v25, s6, v105
    v_mul_f32 v26, s6, v106
    v_mul_f32 v27, s6, v107
    v_mul_f32 v28, s6, v108
    v_mul_f32 v29, s6, v109
    v_mul_f32 v30, s6, v110
    v_mul_f32 v31, s6, v111
    v_exp_f32 v16, v16
    v_exp_f32 v17, v17
    v_exp_f32 v18, v18
    v_exp_f32 v19, v19
    v_exp_f32 v20, v20
    v_exp_f32 v21, v21
    v_exp_f32 v22, v22
    v_exp_f32 v23, v23
    v_exp_f32 v24, v24
    v_exp_f32 v25, v25
    v_exp_f32 v26, v26
    v_exp_f32 v27, v27
    v_exp_f32 v28, v28
    v_exp_f32 v29, v29
    v_exp_f32 v30, v30
    v_exp_f32 v31, v31
    v_add_f32 v16, 1.0, v16
    v_add_f32 v17, 1.0, v17
    v_add_f32 v18, 1.0, v18
    v_add_f32 v19, 1.0, v19
    v_add_f32 v20, 1.0, v20
    v_add_f32 v21, 1.0, v21
    v_add_f32 v22, 1.0, v22
    v_add_f32 v23, 1.0, v23
    v_add_f32 v24, 1.0, v24
    v_add_f32 v25, 1.0, v25
    v_add_f32 v26, 1.0, v26
    v_add_f32 v27, 1.0, v27
    v_add_f32 v28, 1.0, v28
    v_add_f32 v29, 1.0, v29
    v_add_f32 v30, 1.0, v30
    v_add_f32 v31, 1.0, v31
    v_rcp_f32 v16, v16
    v_rcp_f32 v17, v17
    v_rcp_f32 v18, v18
    v_rcp_f32 v19, v19
    v_rcp_f32 v20, v20
    v_rcp_f32 v21, v21
    v_rcp_f32 v22, v22
    v_rcp_f32 v23, v23
    v_rcp_f32 v24, v24
    v_rcp_f32 v25, v25
    v_rcp_f32 v26, v26
    v_rcp_f32 v27, v27
    v_rcp_f32 v28, v28
    v_rcp_f32 v29, v29
    v_rcp_f32 v30, v30
    v_rcp_f32 v31, v31
    v_mul_f32 v96, v160, v16
    v_mul_f32 v97, v161, v17
    v_mul_f32 v98, v162, v18
    v_mul_f32 v99, v163, v19
    v_mul_f32 v100, v164, v20
    v_mul_f32 v101, v165, v21
    v_mul_f32 v102, v166, v22
    v_mul_f32 v103, v167, v23
    v_mul_f32 v104, v168, v24
    v_mul_f32 v105, v169, v25
    v_mul_f32 v106, v170, v26
    v_mul_f32 v107, v171, v27
    v_mul_f32 v108, v172, v28
    v_mul_f32 v109, v173, v29
    v_mul_f32 v110, v174, v30
    v_mul_f32 v111, v175, v31
    v_cvt_pk_bf16_f32 v32, v96, v97
    v_cvt_pk_bf16_f32 v33, v98, v99
    v_cvt_pk_bf16_f32 v34, v100, v101
    v_cvt_pk_bf16_f32 v35, v102, v103
    v_cvt_pk_bf16_f32 v36, v104, v105
    v_cvt_pk_bf16_f32 v37, v106, v107
    v_cvt_pk_bf16_f32 v38, v108, v109
    v_cvt_pk_bf16_f32 v39, v110, v111
    s_add_u32 s7, s101, 0
    v_xor_b32 v243, s7, v245
    v_lshl_add_u32 v243, v243, 4, v244
    ds_write_b64 v243, v[32:33] offset:0
    ds_write_b64 v243, v[34:35] offset:4096
    ds_write_b64 v243, v[36:37] offset:8192
    ds_write_b64 v243, v[38:39] offset:12288
    v_mul_f32 v16, s6, v112
    v_mul_f32 v17, s6, v113
    v_mul_f32 v18, s6, v114
    v_mul_f32 v19, s6, v115
    v_mul_f32 v20, s6, v116
    v_mul_f32 v21, s6, v117
    v_mul_f32 v22, s6, v118
    v_mul_f32 v23, s6, v119
    v_mul_f32 v24, s6, v120
    v_mul_f32 v25, s6, v121
    v_mul_f32 v26, s6, v122
    v_mul_f32 v27, s6, v123
    v_mul_f32 v28, s6, v124
    v_mul_f32 v29, s6, v125
    v_mul_f32 v30, s6, v126
    v_mul_f32 v31, s6, v127
    v_exp_f32 v16, v16
    v_exp_f32 v17, v17
    v_exp_f32 v18, v18
    v_exp_f32 v19, v19
    v_exp_f32 v20, v20
    v_exp_f32 v21, v21
    v_exp_f32 v22, v22
    v_exp_f32 v23, v23
    v_exp_f32 v24, v24
    v_exp_f32 v25, v25
    v_exp_f32 v26, v26
    v_exp_f32 v27, v27
    v_exp_f32 v28, v28
    v_exp_f32 v29, v29
    v_exp_f32 v30, v30
    v_exp_f32 v31, v31
    v_add_f32 v16, 1.0, v16
    v_add_f32 v17, 1.0, v17
    v_add_f32 v18, 1.0, v18
    v_add_f32 v19, 1.0, v19
    v_add_f32 v20, 1.0, v20
    v_add_f32 v21, 1.0, v21
    v_add_f32 v22, 1.0, v22
    v_add_f32 v23, 1.0, v23
    v_add_f32 v24, 1.0, v24
    v_add_f32 v25, 1.0, v25
    v_add_f32 v26, 1.0, v26
    v_add_f32 v27, 1.0, v27
    v_add_f32 v28, 1.0, v28
    v_add_f32 v29, 1.0, v29
    v_add_f32 v30, 1.0, v30
    v_add_f32 v31, 1.0, v31
    v_rcp_f32 v16, v16
    v_rcp_f32 v17, v17
    v_rcp_f32 v18, v18
    v_rcp_f32 v19, v19
    v_rcp_f32 v20, v20
    v_rcp_f32 v21, v21
    v_rcp_f32 v22, v22
    v_rcp_f32 v23, v23
    v_rcp_f32 v24, v24
    v_rcp_f32 v25, v25
    v_rcp_f32 v26, v26
    v_rcp_f32 v27, v27
    v_rcp_f32 v28, v28
    v_rcp_f32 v29, v29
    v_rcp_f32 v30, v30
    v_rcp_f32 v31, v31
    v_mul_f32 v112, v176, v16
    v_mul_f32 v113, v177, v17
    v_mul_f32 v114, v178, v18
    v_mul_f32 v115, v179, v19
    v_mul_f32 v116, v180, v20
    v_mul_f32 v117, v181, v21
    v_mul_f32 v118, v182, v22
    v_mul_f32 v119, v183, v23
    v_mul_f32 v120, v184, v24
    v_mul_f32 v121, v185, v25
    v_mul_f32 v122, v186, v26
    v_mul_f32 v123, v187, v27
    v_mul_f32 v124, v188, v28
    v_mul_f32 v125, v189, v29
    v_mul_f32 v126, v190, v30
    v_mul_f32 v127, v191, v31
    v_cvt_pk_bf16_f32 v32, v112, v113
    v_cvt_pk_bf16_f32 v33, v114, v115
    v_cvt_pk_bf16_f32 v34, v116, v117
    v_cvt_pk_bf16_f32 v35, v118, v119
    v_cvt_pk_bf16_f32 v36, v120, v121
    v_cvt_pk_bf16_f32 v37, v122, v123
    v_cvt_pk_bf16_f32 v38, v124, v125
    v_cvt_pk_bf16_f32 v39, v126, v127
    s_add_u32 s7, s101, 2
    v_xor_b32 v243, s7, v245
    v_lshl_add_u32 v243, v243, 4, v244
    ds_write_b64 v243, v[32:33] offset:0
    ds_write_b64 v243, v[34:35] offset:4096
    ds_write_b64 v243, v[36:37] offset:8192
    ds_write_b64 v243, v[38:39] offset:12288
    v_mul_f32 v16, s6, v128
    v_mul_f32 v17, s6, v129
    v_mul_f32 v18, s6, v130
    v_mul_f32 v19, s6, v131
    v_mul_f32 v20, s6, v132
    v_mul_f32 v21, s6, v133
    v_mul_f32 v22, s6, v134
    v_mul_f32 v23, s6, v135
    v_mul_f32 v24, s6, v136
    v_mul_f32 v25, s6, v137
    v_mul_f32 v26, s6, v138
    v_mul_f32 v27, s6, v139
    v_mul_f32 v28, s6, v140
    v_mul_f32 v29, s6, v141
    v_mul_f32 v30, s6, v142
    v_mul_f32 v31, s6, v143
    v_exp_f32 v16, v16
    v_exp_f32 v17, v17
    v_exp_f32 v18, v18
    v_exp_f32 v19, v19
    v_exp_f32 v20, v20
    v_exp_f32 v21, v21
    v_exp_f32 v22, v22
    v_exp_f32 v23, v23
    v_exp_f32 v24, v24
    v_exp_f32 v25, v25
    v_exp_f32 v26, v26
    v_exp_f32 v27, v27
    v_exp_f32 v28, v28
    v_exp_f32 v29, v29
    v_exp_f32 v30, v30
    v_exp_f32 v31, v31
    v_add_f32 v16, 1.0, v16
    v_add_f32 v17, 1.0, v17
    v_add_f32 v18, 1.0, v18
    v_add_f32 v19, 1.0, v19
    v_add_f32 v20, 1.0, v20
    v_add_f32 v21, 1.0, v21
    v_add_f32 v22, 1.0, v22
    v_add_f32 v23, 1.0, v23
    v_add_f32 v24, 1.0, v24
    v_add_f32 v25, 1.0, v25
    v_add_f32 v26, 1.0, v26
    v_add_f32 v27, 1.0, v27
    v_add_f32 v28, 1.0, v28
    v_add_f32 v29, 1.0, v29
    v_add_f32 v30, 1.0, v30
    v_add_f32 v31, 1.0, v31
    v_rcp_f32 v16, v16
    v_rcp_f32 v17, v17
    v_rcp_f32 v18, v18
    v_rcp_f32 v19, v19
    v_rcp_f32 v20, v20
    v_rcp_f32 v21, v21
    v_rcp_f32 v22, v22
    v_rcp_f32 v23, v23
    v_rcp_f32 v24, v24
    v_rcp_f32 v25, v25
    v_rcp_f32 v26, v26
    v_rcp_f32 v27, v27
    v_rcp_f32 v28, v28
    v_rcp_f32 v29, v29
    v_rcp_f32 v30, v30
    v_rcp_f32 v31, v31
    v_mul_f32 v128, v192, v16
    v_mul_f32 v129, v193, v17
    v_mul_f32 v130, v194, v18
    v_mul_f32 v131, v195, v19
    v_mul_f32 v132, v196, v20
    v_mul_f32 v133, v197, v21
    v_mul_f32 v134, v198, v22
    v_mul_f32 v135, v199, v23
    v_mul_f32 v136, v200, v24
    v_mul_f32 v137, v201, v25
    v_mul_f32 v138, v202, v26
    v_mul_f32 v139, v203, v27
    v_mul_f32 v140, v204, v28
    v_mul_f32 v141, v205, v29
    v_mul_f32 v142, v206, v30
    v_mul_f32 v143, v207, v31
    v_cvt_pk_bf16_f32 v32, v128, v129
    v_cvt_pk_bf16_f32 v33, v130, v131
    v_cvt_pk_bf16_f32 v34, v132, v133
    v_cvt_pk_bf16_f32 v35, v134, v135
    v_cvt_pk_bf16_f32 v36, v136, v137
    v_cvt_pk_bf16_f32 v37, v138, v139
    v_cvt_pk_bf16_f32 v38, v140, v141
    v_cvt_pk_bf16_f32 v39, v142, v143
    s_add_u32 s7, s101, 4
    v_xor_b32 v243, s7, v245
    v_lshl_add_u32 v243, v243, 4, v244
    ds_write_b64 v243, v[32:33] offset:0
    ds_write_b64 v243, v[34:35] offset:4096
    ds_write_b64 v243, v[36:37] offset:8192
    ds_write_b64 v243, v[38:39] offset:12288
    v_mul_f32 v16, s6, v144
    v_mul_f32 v17, s6, v145
    v_mul_f32 v18, s6, v146
    v_mul_f32 v19, s6, v147
    v_mul_f32 v20, s6, v148
    v_mul_f32 v21, s6, v149
    v_mul_f32 v22, s6, v150
    v_mul_f32 v23, s6, v151
    v_mul_f32 v24, s6, v152
    v_mul_f32 v25, s6, v153
    v_mul_f32 v26, s6, v154
    v_mul_f32 v27, s6, v155
    v_mul_f32 v28, s6, v156
    v_mul_f32 v29, s6, v157
    v_mul_f32 v30, s6, v158
    v_mul_f32 v31, s6, v159
    v_exp_f32 v16, v16
    v_exp_f32 v17, v17
    v_exp_f32 v18, v18
    v_exp_f32 v19, v19
    v_exp_f32 v20, v20
    v_exp_f32 v21, v21
    v_exp_f32 v22, v22
    v_exp_f32 v23, v23
    v_exp_f32 v24, v24
    v_exp_f32 v25, v25
    v_exp_f32 v26, v26
    v_exp_f32 v27, v27
    v_exp_f32 v28, v28
    v_exp_f32 v29, v29
    v_exp_f32 v30, v30
    v_exp_f32 v31, v31
    v_add_f32 v16, 1.0, v16
    v_add_f32 v17, 1.0, v17
    v_add_f32 v18, 1.0, v18
    v_add_f32 v19, 1.0, v19
    v_add_f32 v20, 1.0, v20
    v_add_f32 v21, 1.0, v21
    v_add_f32 v22, 1.0, v22
    v_add_f32 v23, 1.0, v23
    v_add_f32 v24, 1.0, v24
    v_add_f32 v25, 1.0, v25
    v_add_f32 v26, 1.0, v26
    v_add_f32 v27, 1.0, v27
    v_add_f32 v28, 1.0, v28
    v_add_f32 v29, 1.0, v29
    v_add_f32 v30, 1.0, v30
    v_add_f32 v31, 1.0, v31
    v_rcp_f32 v16, v16
    v_rcp_f32 v17, v17
    v_rcp_f32 v18, v18
    v_rcp_f32 v19, v19
    v_rcp_f32 v20, v20
    v_rcp_f32 v21, v21
    v_rcp_f32 v22, v22
    v_rcp_f32 v23, v23
    v_rcp_f32 v24, v24
    v_rcp_f32 v25, v25
    v_rcp_f32 v26, v26
    v_rcp_f32 v27, v27
    v_rcp_f32 v28, v28
    v_rcp_f32 v29, v29
    v_rcp_f32 v30, v30
    v_rcp_f32 v31, v31
    v_mul_f32 v144, v208, v16
    v_mul_f32 v145, v209, v17
    v_mul_f32 v146, v210, v18
    v_mul_f32 v147, v211, v19
    v_mul_f32 v148, v212, v20
    v_mul_f32 v149, v213, v21
    v_mul_f32 v150, v214, v22
    v_mul_f32 v151, v215, v23
    v_mul_f32 v152, v216, v24
    v_mul_f32 v153, v217, v25
    v_mul_f32 v154, v218, v26
    v_mul_f32 v155, v219, v27
    v_mul_f32 v156, v220, v28
    v_mul_f32 v157, v221, v29
    v_mul_f32 v158, v222, v30
    v_mul_f32 v159, v223, v31
    v_cvt_pk_bf16_f32 v32, v144, v145
    v_cvt_pk_bf16_f32 v33, v146, v147
    v_cvt_pk_bf16_f32 v34, v148, v149
    v_cvt_pk_bf16_f32 v35, v150, v151
    v_cvt_pk_bf16_f32 v36, v152, v153
    v_cvt_pk_bf16_f32 v37, v154, v155
    v_cvt_pk_bf16_f32 v38, v156, v157
    v_cvt_pk_bf16_f32 v39, v158, v159
    s_add_u32 s7, s101, 6
    v_xor_b32 v243, s7, v245
    v_lshl_add_u32 v243, v243, 4, v244
    ds_write_b64 v243, v[32:33] offset:0
    ds_write_b64 v243, v[34:35] offset:4096
    ds_write_b64 v243, v[36:37] offset:8192
    ds_write_b64 v243, v[38:39] offset:12288
    s_lshr_b32 s7, s3, 1
    s_mul_i32 s7, s7, 1
    s_add_u32 s7, s7, 0
    s_lshr_b32 s7, s7, 1
    s_add_u32 s7, s7, s99
    s_cmp_lt_u32 s7, 16
    s_cselect_b32 s84, 0, 0x80008000
    v_cvt_pk_bf16_f32 v48, v224, v225
    v_cvt_pk_bf16_f32 v49, v226, v227
    v_cvt_pk_bf16_f32 v50, v228, v229
    v_cvt_pk_bf16_f32 v51, v230, v231
    v_cvt_pk_bf16_f32 v52, v232, v233
    v_cvt_pk_bf16_f32 v53, v234, v235
    v_cvt_pk_bf16_f32 v54, v236, v237
    v_cvt_pk_bf16_f32 v55, v238, v239
    v_xor_b32 v48, s84, v48
    v_xor_b32 v49, s84, v49
    v_xor_b32 v50, s84, v50
    v_xor_b32 v51, s84, v51
    v_xor_b32 v52, s84, v52
    v_xor_b32 v53, s84, v53
    v_xor_b32 v54, s84, v54
    v_xor_b32 v55, s84, v55
    v_xor_b32 v243, 0, v247
    v_lshl_add_u32 v243, v243, 4, v246
    ds_write_b64 v243, v[48:49] offset:0
    v_xor_b32 v243, 2, v247
    v_lshl_add_u32 v243, v243, 4, v246
    ds_write_b64 v243, v[50:51] offset:0
    v_xor_b32 v243, 4, v247
    v_lshl_add_u32 v243, v243, 4, v246
    ds_write_b64 v243, v[52:53] offset:0
    v_xor_b32 v243, 6, v247
    v_lshl_add_u32 v243, v243, 4, v246
    ds_write_b64 v243, v[54:55] offset:0
    s_waitcnt lgkmcnt(0)
    s_branch K1_STB
K1_CC:
    s_lshr_b32 s101, s3, 1
    s_and_b32 s84, s3, 1
    v_and_b32 v240, 15, v2
    v_lshrrev_b32 v241, 1, v240
    v_lshrrev_b32 v242, 4, v2
    v_xor_b32 v241, v241, v242
    v_lshlrev_b32 v241, 4, v241
    v_lshlrev_b32 v242, 7, v240
    s_lshl_b32 s6, s84, 13
    s_mul_i32 s7, s101, 10240
    s_add_u32 s7, s7, 0x8000
    v_xor_b32 v243, 0, v241
    v_add3_u32 v8, v243, v242, s6
    v_add3_u32 v10, v243, v242, s7
    v_xor_b32 v243, 64, v241
    v_add3_u32 v9, v243, v242, s6
    v_add3_u32 v11, v243, v242, s7
    v_lshrrev_b32 v240, 4, v2
    v_bfe_u32 v241, v2, 2, 2
    v_lshl_add_u32 v242, v240, 3, v241
    s_movk_i32 s6, 128
    v_mul_lo_u32 v242, v242, s6
    v_and_b32 v243, 1, v2
    v_lshl_add_u32 v242, v243, 3, v242
    v_add_u32 v242, 16384, v242
    v_and_b32 v240, 1, v240
    v_lshrrev_b32 v241, 1, v241
    v_lshl_add_u32 v241, v240, 1, v241
    v_lshlrev_b32 v241, 1, v241
    v_bfe_u32 v240, v2, 1, 1
    v_xor_b32 v241, v241, v240
    s_mul_i32 s6, s101, 4
    s_add_u32 s7, s6, 0
    v_xor_b32 v243, s7, v241
    v_lshl_add_u32 v4, v243, 4, v242
    s_add_u32 s7, s6, 2
    v_xor_b32 v243, s7, v241
    v_lshl_add_u32 v5, v243, 4, v242
    s_barrier
    v_add_u32 v244, 0x0, v4
    v_add_u32 v245, 0x0, v5
    v_add_u32 v248, 0x0, v8
    v_add_u32 v250, 0x0, v10
    v_add_u32 v249, 0x0, v9
    v_add_u32 v251, 0x0, v11
    ds_read_b128 v[16:19], v248 offset:0
    ds_read_b128 v[20:23], v248 offset:2048
    ds_read_b128 v[24:27], v248 offset:4096
    ds_read_b128 v[28:31], v248 offset:6144
    ds_read_b64_tr_b16 v[48:49], v244 offset:0
    ds_read_b64_tr_b16 v[50:51], v244 offset:512
    ds_read_b64_tr_b16 v[52:53], v245 offset:0
    ds_read_b64_tr_b16 v[54:55], v245 offset:512
    ds_read_b64_tr_b16 v[56:57], v244 offset:8192
    ds_read_b64_tr_b16 v[58:59], v244 offset:8704
    ds_read_b64_tr_b16 v[60:61], v245 offset:8192
    ds_read_b64_tr_b16 v[62:63], v245 offset:8704
    ds_read_b128 v[64:67], v250 offset:0
    ds_read_b128 v[68:71], v250 offset:2048
    ds_read_b128 v[72:75], v250 offset:4096
    ds_read_b128 v[76:79], v250 offset:6144
    ds_read_b128 v[80:83], v250 offset:8192
    s_waitcnt lgkmcnt(13)
    s_waitcnt lgkmcnt(11)
    v_mfma_f32_16x16x32_bf16 v[96:99], v[48:51], v[16:19], 0
    v_mfma_f32_16x16x32_bf16 v[100:103], v[48:51], v[20:23], 0
    v_mfma_f32_16x16x32_bf16 v[104:107], v[48:51], v[24:27], 0
    v_mfma_f32_16x16x32_bf16 v[108:111], v[48:51], v[28:31], 0
    ds_read_b64_tr_b16 v[48:49], v244 offset:4096
    ds_read_b64_tr_b16 v[50:51], v244 offset:4608
    s_waitcnt lgkmcnt(11)
    v_mfma_f32_16x16x32_bf16 v[112:115], v[52:55], v[16:19], 0
    ds_read_b128 v[32:35], v249 offset:0
    v_mfma_f32_16x16x32_bf16 v[116:119], v[52:55], v[20:23], 0
    ds_read_b128 v[36:39], v249 offset:2048
    v_mfma_f32_16x16x32_bf16 v[120:123], v[52:55], v[24:27], 0
    ds_read_b128 v[40:43], v249 offset:4096
    v_mfma_f32_16x16x32_bf16 v[124:127], v[52:55], v[28:31], 0
    ds_read_b128 v[44:47], v249 offset:6144
    ds_read_b64_tr_b16 v[52:53], v245 offset:4096
    ds_read_b64_tr_b16 v[54:55], v245 offset:4608
    s_waitcnt lgkmcnt(15)
    v_mfma_f32_16x16x32_bf16 v[128:131], v[56:59], v[16:19], 0
    v_mfma_f32_16x16x32_bf16 v[132:135], v[56:59], v[20:23], 0
    v_mfma_f32_16x16x32_bf16 v[136:139], v[56:59], v[24:27], 0
    v_mfma_f32_16x16x32_bf16 v[140:143], v[56:59], v[28:31], 0
    ds_read_b64_tr_b16 v[56:57], v244 offset:12288
    ds_read_b64_tr_b16 v[58:59], v244 offset:12800
    s_waitcnt lgkmcnt(15)
    v_mfma_f32_16x16x32_bf16 v[144:147], v[60:63], v[16:19], 0
    v_mfma_f32_16x16x32_bf16 v[148:151], v[60:63], v[20:23], 0
    v_mfma_f32_16x16x32_bf16 v[152:155], v[60:63], v[24:27], 0
    v_mfma_f32_16x16x32_bf16 v[156:159], v[60:63], v[28:31], 0
    ds_read_b64_tr_b16 v[60:61], v245 offset:12288
    ds_read_b64_tr_b16 v[62:63], v245 offset:12800
    s_waitcnt lgkmcnt(15)
    v_mfma_f32_16x16x32_bf16 v[160:163], v[16:19], v[64:67], 0
    v_mfma_f32_16x16x32_bf16 v[164:167], v[20:23], v[64:67], 0
    v_mfma_f32_16x16x32_bf16 v[168:171], v[24:27], v[64:67], 0
    v_mfma_f32_16x16x32_bf16 v[172:175], v[28:31], v[64:67], 0
    ds_read_b128 v[64:67], v251 offset:0
    s_waitcnt lgkmcnt(15)
    v_mfma_f32_16x16x32_bf16 v[176:179], v[16:19], v[68:71], 0
    v_mfma_f32_16x16x32_bf16 v[180:183], v[20:23], v[68:71], 0
    v_mfma_f32_16x16x32_bf16 v[184:187], v[24:27], v[68:71], 0
    v_mfma_f32_16x16x32_bf16 v[188:191], v[28:31], v[68:71], 0
    ds_read_b128 v[68:71], v251 offset:2048
    s_waitcnt lgkmcnt(15)
    v_mfma_f32_16x16x32_bf16 v[192:195], v[16:19], v[72:75], 0
    v_mfma_f32_16x16x32_bf16 v[196:199], v[20:23], v[72:75], 0
    v_mfma_f32_16x16x32_bf16 v[200:203], v[24:27], v[72:75], 0
    v_mfma_f32_16x16x32_bf16 v[204:207], v[28:31], v[72:75], 0
    ds_read_b128 v[72:75], v251 offset:4096
    s_waitcnt lgkmcnt(15)
    v_mfma_f32_16x16x32_bf16 v[208:211], v[16:19], v[76:79], 0
    v_mfma_f32_16x16x32_bf16 v[212:215], v[20:23], v[76:79], 0
    v_mfma_f32_16x16x32_bf16 v[216:219], v[24:27], v[76:79], 0
    v_mfma_f32_16x16x32_bf16 v[220:223], v[28:31], v[76:79], 0
    ds_read_b128 v[76:79], v251 offset:6144
    s_waitcnt lgkmcnt(15)
    v_mfma_f32_16x16x32_bf16 v[224:227], v[16:19], v[80:83], 0
    v_mfma_f32_16x16x32_bf16 v[228:231], v[20:23], v[80:83], 0
    v_mfma_f32_16x16x32_bf16 v[232:235], v[24:27], v[80:83], 0
    v_mfma_f32_16x16x32_bf16 v[236:239], v[28:31], v[80:83], 0
    ds_read_b128 v[80:83], v251 offset:8192
    s_waitcnt lgkmcnt(0)
    s_barrier
    v_mfma_f32_16x16x32_bf16 v[96:99], v[48:51], v[32:35], v[96:99]
    v_add_u32 v244, 0xd000, v4
    v_add_u32 v245, 0xd000, v5
    v_mfma_f32_16x16x32_bf16 v[100:103], v[48:51], v[36:39], v[100:103]
    v_add_u32 v248, 0xd000, v8
    v_add_u32 v250, 0xd000, v10
    v_mfma_f32_16x16x32_bf16 v[104:107], v[48:51], v[40:43], v[104:107]
    v_add_u32 v249, 0xd000, v9
    v_add_u32 v251, 0xd000, v11
    v_mfma_f32_16x16x32_bf16 v[108:111], v[48:51], v[44:47], v[108:111]
    ds_read_b64_tr_b16 v[48:49], v244 offset:0
    ds_read_b64_tr_b16 v[50:51], v244 offset:512
    v_mfma_f32_16x16x32_bf16 v[112:115], v[52:55], v[32:35], v[112:115]
    ds_read_b128 v[16:19], v248 offset:0
    v_mfma_f32_16x16x32_bf16 v[116:119], v[52:55], v[36:39], v[116:119]
    ds_read_b128 v[20:23], v248 offset:2048
    v_mfma_f32_16x16x32_bf16 v[120:123], v[52:55], v[40:43], v[120:123]
    ds_read_b128 v[24:27], v248 offset:4096
    v_mfma_f32_16x16x32_bf16 v[124:127], v[52:55], v[44:47], v[124:127]
    ds_read_b128 v[28:31], v248 offset:6144
    ds_read_b64_tr_b16 v[52:53], v245 offset:0
    ds_read_b64_tr_b16 v[54:55], v245 offset:512
    v_mfma_f32_16x16x32_bf16 v[128:131], v[56:59], v[32:35], v[128:131]
    v_mfma_f32_16x16x32_bf16 v[132:135], v[56:59], v[36:39], v[132:135]
    v_mfma_f32_16x16x32_bf16 v[136:139], v[56:59], v[40:43], v[136:139]
    v_mfma_f32_16x16x32_bf16 v[140:143], v[56:59], v[44:47], v[140:143]
    ds_read_b64_tr_b16 v[56:57], v244 offset:8192
    ds_read_b64_tr_b16 v[58:59], v244 offset:8704
    v_mfma_f32_16x16x32_bf16 v[144:147], v[60:63], v[32:35], v[144:147]
    v_mfma_f32_16x16x32_bf16 v[148:151], v[60:63], v[36:39], v[148:151]
    v_mfma_f32_16x16x32_bf16 v[152:155], v[60:63], v[40:43], v[152:155]
    v_mfma_f32_16x16x32_bf16 v[156:159], v[60:63], v[44:47], v[156:159]
    ds_read_b64_tr_b16 v[60:61], v245 offset:8192
    ds_read_b64_tr_b16 v[62:63], v245 offset:8704
    v_mfma_f32_16x16x32_bf16 v[160:163], v[32:35], v[64:67], v[160:163]
    v_mfma_f32_16x16x32_bf16 v[164:167], v[36:39], v[64:67], v[164:167]
    v_mfma_f32_16x16x32_bf16 v[168:171], v[40:43], v[64:67], v[168:171]
    v_mfma_f32_16x16x32_bf16 v[172:175], v[44:47], v[64:67], v[172:175]
    ds_read_b128 v[64:67], v250 offset:0
    v_mfma_f32_16x16x32_bf16 v[176:179], v[32:35], v[68:71], v[176:179]
    v_mfma_f32_16x16x32_bf16 v[180:183], v[36:39], v[68:71], v[180:183]
    v_mfma_f32_16x16x32_bf16 v[184:187], v[40:43], v[68:71], v[184:187]
    v_mfma_f32_16x16x32_bf16 v[188:191], v[44:47], v[68:71], v[188:191]
    ds_read_b128 v[68:71], v250 offset:2048
    v_mfma_f32_16x16x32_bf16 v[192:195], v[32:35], v[72:75], v[192:195]
    v_mfma_f32_16x16x32_bf16 v[196:199], v[36:39], v[72:75], v[196:199]
    v_mfma_f32_16x16x32_bf16 v[200:203], v[40:43], v[72:75], v[200:203]
    v_mfma_f32_16x16x32_bf16 v[204:207], v[44:47], v[72:75], v[204:207]
    ds_read_b128 v[72:75], v250 offset:4096
    v_mfma_f32_16x16x32_bf16 v[208:211], v[32:35], v[76:79], v[208:211]
    v_mfma_f32_16x16x32_bf16 v[212:215], v[36:39], v[76:79], v[212:215]
    v_mfma_f32_16x16x32_bf16 v[216:219], v[40:43], v[76:79], v[216:219]
    v_mfma_f32_16x16x32_bf16 v[220:223], v[44:47], v[76:79], v[220:223]
    ds_read_b128 v[76:79], v250 offset:6144
    v_mfma_f32_16x16x32_bf16 v[224:227], v[32:35], v[80:83], v[224:227]
    v_mfma_f32_16x16x32_bf16 v[228:231], v[36:39], v[80:83], v[228:231]
    v_mfma_f32_16x16x32_bf16 v[232:235], v[40:43], v[80:83], v[232:235]
    v_mfma_f32_16x16x32_bf16 v[236:239], v[44:47], v[80:83], v[236:239]
    ds_read_b128 v[80:83], v250 offset:8192
    s_waitcnt lgkmcnt(11)
    v_mfma_f32_16x16x32_bf16 v[96:99], v[48:51], v[16:19], v[96:99]
    v_mfma_f32_16x16x32_bf16 v[100:103], v[48:51], v[20:23], v[100:103]
    v_mfma_f32_16x16x32_bf16 v[104:107], v[48:51], v[24:27], v[104:107]
    v_mfma_f32_16x16x32_bf16 v[108:111], v[48:51], v[28:31], v[108:111]
    ds_read_b64_tr_b16 v[48:49], v244 offset:4096
    ds_read_b64_tr_b16 v[50:51], v244 offset:4608
    s_waitcnt lgkmcnt(11)
    v_mfma_f32_16x16x32_bf16 v[112:115], v[52:55], v[16:19], v[112:115]
    ds_read_b128 v[32:35], v249 offset:0
    v_mfma_f32_16x16x32_bf16 v[116:119], v[52:55], v[20:23], v[116:119]
    ds_read_b128 v[36:39], v249 offset:2048
    v_mfma_f32_16x16x32_bf16 v[120:123], v[52:55], v[24:27], v[120:123]
    ds_read_b128 v[40:43], v249 offset:4096
    v_mfma_f32_16x16x32_bf16 v[124:127], v[52:55], v[28:31], v[124:127]
    ds_read_b128 v[44:47], v249 offset:6144
    ds_read_b64_tr_b16 v[52:53], v245 offset:4096
    ds_read_b64_tr_b16 v[54:55], v245 offset:4608
    s_waitcnt lgkmcnt(15)
    v_mfma_f32_16x16x32_bf16 v[128:131], v[56:59], v[16:19], v[128:131]
    v_mfma_f32_16x16x32_bf16 v[132:135], v[56:59], v[20:23], v[132:135]
    v_mfma_f32_16x16x32_bf16 v[136:139], v[56:59], v[24:27], v[136:139]
    v_mfma_f32_16x16x32_bf16 v[140:143], v[56:59], v[28:31], v[140:143]
    ds_read_b64_tr_b16 v[56:57], v244 offset:12288
    ds_read_b64_tr_b16 v[58:59], v244 offset:12800
    s_waitcnt lgkmcnt(15)
    v_mfma_f32_16x16x32_bf16 v[144:147], v[60:63], v[16:19], v[144:147]
    v_mfma_f32_16x16x32_bf16 v[148:151], v[60:63], v[20:23], v[148:151]
    v_mfma_f32_16x16x32_bf16 v[152:155], v[60:63], v[24:27], v[152:155]
    v_mfma_f32_16x16x32_bf16 v[156:159], v[60:63], v[28:31], v[156:159]
    ds_read_b64_tr_b16 v[60:61], v245 offset:12288
    ds_read_b64_tr_b16 v[62:63], v245 offset:12800
    s_waitcnt lgkmcnt(15)
    v_mfma_f32_16x16x32_bf16 v[160:163], v[16:19], v[64:67], v[160:163]
    v_mfma_f32_16x16x32_bf16 v[164:167], v[20:23], v[64:67], v[164:167]
    v_mfma_f32_16x16x32_bf16 v[168:171], v[24:27], v[64:67], v[168:171]
    v_mfma_f32_16x16x32_bf16 v[172:175], v[28:31], v[64:67], v[172:175]
    ds_read_b128 v[64:67], v251 offset:0
    s_waitcnt lgkmcnt(15)
    v_mfma_f32_16x16x32_bf16 v[176:179], v[16:19], v[68:71], v[176:179]
    v_mfma_f32_16x16x32_bf16 v[180:183], v[20:23], v[68:71], v[180:183]
    v_mfma_f32_16x16x32_bf16 v[184:187], v[24:27], v[68:71], v[184:187]
    v_mfma_f32_16x16x32_bf16 v[188:191], v[28:31], v[68:71], v[188:191]
    ds_read_b128 v[68:71], v251 offset:2048
    s_waitcnt lgkmcnt(15)
    v_mfma_f32_16x16x32_bf16 v[192:195], v[16:19], v[72:75], v[192:195]
    v_mfma_f32_16x16x32_bf16 v[196:199], v[20:23], v[72:75], v[196:199]
    v_mfma_f32_16x16x32_bf16 v[200:203], v[24:27], v[72:75], v[200:203]
    v_mfma_f32_16x16x32_bf16 v[204:207], v[28:31], v[72:75], v[204:207]
    ds_read_b128 v[72:75], v251 offset:4096
    s_waitcnt lgkmcnt(15)
    v_mfma_f32_16x16x32_bf16 v[208:211], v[16:19], v[76:79], v[208:211]
    v_mfma_f32_16x16x32_bf16 v[212:215], v[20:23], v[76:79], v[212:215]
    v_mfma_f32_16x16x32_bf16 v[216:219], v[24:27], v[76:79], v[216:219]
    v_mfma_f32_16x16x32_bf16 v[220:223], v[28:31], v[76:79], v[220:223]
    ds_read_b128 v[76:79], v251 offset:6144
    s_waitcnt lgkmcnt(15)
    v_mfma_f32_16x16x32_bf16 v[224:227], v[16:19], v[80:83], v[224:227]
    v_mfma_f32_16x16x32_bf16 v[228:231], v[20:23], v[80:83], v[228:231]
    v_mfma_f32_16x16x32_bf16 v[232:235], v[24:27], v[80:83], v[232:235]
    v_mfma_f32_16x16x32_bf16 v[236:239], v[28:31], v[80:83], v[236:239]
    ds_read_b128 v[80:83], v251 offset:8192
    s_waitcnt lgkmcnt(0)
    s_barrier
    v_mfma_f32_16x16x32_bf16 v[96:99], v[48:51], v[32:35], v[96:99]
    v_add_u32 v244, 0x1a000, v4
    v_add_u32 v245, 0x1a000, v5
    v_mfma_f32_16x16x32_bf16 v[100:103], v[48:51], v[36:39], v[100:103]
    v_add_u32 v248, 0x1a000, v8
    v_add_u32 v250, 0x1a000, v10
    v_mfma_f32_16x16x32_bf16 v[104:107], v[48:51], v[40:43], v[104:107]
    v_add_u32 v249, 0x1a000, v9
    v_add_u32 v251, 0x1a000, v11
    v_mfma_f32_16x16x32_bf16 v[108:111], v[48:51], v[44:47], v[108:111]
    ds_read_b64_tr_b16 v[48:49], v244 offset:0
    ds_read_b64_tr_b16 v[50:51], v244 offset:512
    v_mfma_f32_16x16x32_bf16 v[112:115], v[52:55], v[32:35], v[112:115]
    ds_read_b128 v[16:19], v248 offset:0
    v_mfma_f32_16x16x32_bf16 v[116:119], v[52:55], v[36:39], v[116:119]
    ds_read_b128 v[20:23], v248 offset:2048
    v_mfma_f32_16x16x32_bf16 v[120:123], v[52:55], v[40:43], v[120:123]
    ds_read_b128 v[24:27], v248 offset:4096
    v_mfma_f32_16x16x32_bf16 v[124:127], v[52:55], v[44:47], v[124:127]
    ds_read_b128 v[28:31], v248 offset:6144
    ds_read_b64_tr_b16 v[52:53], v245 offset:0
    ds_read_b64_tr_b16 v[54:55], v245 offset:512
    v_mfma_f32_16x16x32_bf16 v[128:131], v[56:59], v[32:35], v[128:131]
    v_mfma_f32_16x16x32_bf16 v[132:135], v[56:59], v[36:39], v[132:135]
    v_mfma_f32_16x16x32_bf16 v[136:139], v[56:59], v[40:43], v[136:139]
    v_mfma_f32_16x16x32_bf16 v[140:143], v[56:59], v[44:47], v[140:143]
    ds_read_b64_tr_b16 v[56:57], v244 offset:8192
    ds_read_b64_tr_b16 v[58:59], v244 offset:8704
    v_mfma_f32_16x16x32_bf16 v[144:147], v[60:63], v[32:35], v[144:147]
    v_mfma_f32_16x16x32_bf16 v[148:151], v[60:63], v[36:39], v[148:151]
    v_mfma_f32_16x16x32_bf16 v[152:155], v[60:63], v[40:43], v[152:155]
    v_mfma_f32_16x16x32_bf16 v[156:159], v[60:63], v[44:47], v[156:159]
    ds_read_b64_tr_b16 v[60:61], v245 offset:8192
    ds_read_b64_tr_b16 v[62:63], v245 offset:8704
    v_mfma_f32_16x16x32_bf16 v[160:163], v[32:35], v[64:67], v[160:163]
    v_mfma_f32_16x16x32_bf16 v[164:167], v[36:39], v[64:67], v[164:167]
    v_mfma_f32_16x16x32_bf16 v[168:171], v[40:43], v[64:67], v[168:171]
    v_mfma_f32_16x16x32_bf16 v[172:175], v[44:47], v[64:67], v[172:175]
    ds_read_b128 v[64:67], v250 offset:0
    v_mfma_f32_16x16x32_bf16 v[176:179], v[32:35], v[68:71], v[176:179]
    v_mfma_f32_16x16x32_bf16 v[180:183], v[36:39], v[68:71], v[180:183]
    v_mfma_f32_16x16x32_bf16 v[184:187], v[40:43], v[68:71], v[184:187]
    v_mfma_f32_16x16x32_bf16 v[188:191], v[44:47], v[68:71], v[188:191]
    ds_read_b128 v[68:71], v250 offset:2048
    v_mfma_f32_16x16x32_bf16 v[192:195], v[32:35], v[72:75], v[192:195]
    v_mfma_f32_16x16x32_bf16 v[196:199], v[36:39], v[72:75], v[196:199]
    v_mfma_f32_16x16x32_bf16 v[200:203], v[40:43], v[72:75], v[200:203]
    v_mfma_f32_16x16x32_bf16 v[204:207], v[44:47], v[72:75], v[204:207]
    ds_read_b128 v[72:75], v250 offset:4096
    v_mfma_f32_16x16x32_bf16 v[208:211], v[32:35], v[76:79], v[208:211]
    v_mfma_f32_16x16x32_bf16 v[212:215], v[36:39], v[76:79], v[212:215]
    v_mfma_f32_16x16x32_bf16 v[216:219], v[40:43], v[76:79], v[216:219]
    v_mfma_f32_16x16x32_bf16 v[220:223], v[44:47], v[76:79], v[220:223]
    ds_read_b128 v[76:79], v250 offset:6144
    v_mfma_f32_16x16x32_bf16 v[224:227], v[32:35], v[80:83], v[224:227]
    v_mfma_f32_16x16x32_bf16 v[228:231], v[36:39], v[80:83], v[228:231]
    v_mfma_f32_16x16x32_bf16 v[232:235], v[40:43], v[80:83], v[232:235]
    v_mfma_f32_16x16x32_bf16 v[236:239], v[44:47], v[80:83], v[236:239]
    ds_read_b128 v[80:83], v250 offset:8192
    s_waitcnt lgkmcnt(11)
    v_mfma_f32_16x16x32_bf16 v[96:99], v[48:51], v[16:19], v[96:99]
    v_mfma_f32_16x16x32_bf16 v[100:103], v[48:51], v[20:23], v[100:103]
    v_mfma_f32_16x16x32_bf16 v[104:107], v[48:51], v[24:27], v[104:107]
    v_mfma_f32_16x16x32_bf16 v[108:111], v[48:51], v[28:31], v[108:111]
    ds_read_b64_tr_b16 v[48:49], v244 offset:4096
    ds_read_b64_tr_b16 v[50:51], v244 offset:4608
    s_waitcnt lgkmcnt(11)
    v_mfma_f32_16x16x32_bf16 v[112:115], v[52:55], v[16:19], v[112:115]
    ds_read_b128 v[32:35], v249 offset:0
    v_mfma_f32_16x16x32_bf16 v[116:119], v[52:55], v[20:23], v[116:119]
    ds_read_b128 v[36:39], v249 offset:2048
    v_mfma_f32_16x16x32_bf16 v[120:123], v[52:55], v[24:27], v[120:123]
    ds_read_b128 v[40:43], v249 offset:4096
    v_mfma_f32_16x16x32_bf16 v[124:127], v[52:55], v[28:31], v[124:127]
    ds_read_b128 v[44:47], v249 offset:6144
    ds_read_b64_tr_b16 v[52:53], v245 offset:4096
    ds_read_b64_tr_b16 v[54:55], v245 offset:4608
    s_waitcnt lgkmcnt(15)
    v_mfma_f32_16x16x32_bf16 v[128:131], v[56:59], v[16:19], v[128:131]
    v_mfma_f32_16x16x32_bf16 v[132:135], v[56:59], v[20:23], v[132:135]
    v_mfma_f32_16x16x32_bf16 v[136:139], v[56:59], v[24:27], v[136:139]
    v_mfma_f32_16x16x32_bf16 v[140:143], v[56:59], v[28:31], v[140:143]
    ds_read_b64_tr_b16 v[56:57], v244 offset:12288
    ds_read_b64_tr_b16 v[58:59], v244 offset:12800
    s_waitcnt lgkmcnt(15)
    v_mfma_f32_16x16x32_bf16 v[144:147], v[60:63], v[16:19], v[144:147]
    v_mfma_f32_16x16x32_bf16 v[148:151], v[60:63], v[20:23], v[148:151]
    v_mfma_f32_16x16x32_bf16 v[152:155], v[60:63], v[24:27], v[152:155]
    v_mfma_f32_16x16x32_bf16 v[156:159], v[60:63], v[28:31], v[156:159]
    ds_read_b64_tr_b16 v[60:61], v245 offset:12288
    ds_read_b64_tr_b16 v[62:63], v245 offset:12800
    s_waitcnt lgkmcnt(15)
    v_mfma_f32_16x16x32_bf16 v[160:163], v[16:19], v[64:67], v[160:163]
    v_mfma_f32_16x16x32_bf16 v[164:167], v[20:23], v[64:67], v[164:167]
    v_mfma_f32_16x16x32_bf16 v[168:171], v[24:27], v[64:67], v[168:171]
    v_mfma_f32_16x16x32_bf16 v[172:175], v[28:31], v[64:67], v[172:175]
    ds_read_b128 v[64:67], v251 offset:0
    s_waitcnt lgkmcnt(15)
    v_mfma_f32_16x16x32_bf16 v[176:179], v[16:19], v[68:71], v[176:179]
    v_mfma_f32_16x16x32_bf16 v[180:183], v[20:23], v[68:71], v[180:183]
    v_mfma_f32_16x16x32_bf16 v[184:187], v[24:27], v[68:71], v[184:187]
    v_mfma_f32_16x16x32_bf16 v[188:191], v[28:31], v[68:71], v[188:191]
    ds_read_b128 v[68:71], v251 offset:2048
    s_waitcnt lgkmcnt(15)
    v_mfma_f32_16x16x32_bf16 v[192:195], v[16:19], v[72:75], v[192:195]
    v_mfma_f32_16x16x32_bf16 v[196:199], v[20:23], v[72:75], v[196:199]
    v_mfma_f32_16x16x32_bf16 v[200:203], v[24:27], v[72:75], v[200:203]
    v_mfma_f32_16x16x32_bf16 v[204:207], v[28:31], v[72:75], v[204:207]
    ds_read_b128 v[72:75], v251 offset:4096
    s_waitcnt lgkmcnt(15)
    v_mfma_f32_16x16x32_bf16 v[208:211], v[16:19], v[76:79], v[208:211]
    v_mfma_f32_16x16x32_bf16 v[212:215], v[20:23], v[76:79], v[212:215]
    v_mfma_f32_16x16x32_bf16 v[216:219], v[24:27], v[76:79], v[216:219]
    v_mfma_f32_16x16x32_bf16 v[220:223], v[28:31], v[76:79], v[220:223]
    ds_read_b128 v[76:79], v251 offset:6144
    s_waitcnt lgkmcnt(15)
    v_mfma_f32_16x16x32_bf16 v[224:227], v[16:19], v[80:83], v[224:227]
    v_mfma_f32_16x16x32_bf16 v[228:231], v[20:23], v[80:83], v[228:231]
    v_mfma_f32_16x16x32_bf16 v[232:235], v[24:27], v[80:83], v[232:235]
    v_mfma_f32_16x16x32_bf16 v[236:239], v[28:31], v[80:83], v[236:239]
    ds_read_b128 v[80:83], v251 offset:8192
    s_waitcnt lgkmcnt(0)
    s_barrier
    v_mfma_f32_16x16x32_bf16 v[96:99], v[48:51], v[32:35], v[96:99]
    v_add_u32 v244, 0x0, v4
    v_add_u32 v245, 0x0, v5
    v_mfma_f32_16x16x32_bf16 v[100:103], v[48:51], v[36:39], v[100:103]
    v_add_u32 v248, 0x0, v8
    v_add_u32 v250, 0x0, v10
    v_mfma_f32_16x16x32_bf16 v[104:107], v[48:51], v[40:43], v[104:107]
    v_add_u32 v249, 0x0, v9
    v_add_u32 v251, 0x0, v11
    v_mfma_f32_16x16x32_bf16 v[108:111], v[48:51], v[44:47], v[108:111]
    ds_read_b64_tr_b16 v[48:49], v244 offset:0
    ds_read_b64_tr_b16 v[50:51], v244 offset:512
    v_mfma_f32_16x16x32_bf16 v[112:115], v[52:55], v[32:35], v[112:115]
    ds_read_b128 v[16:19], v248 offset:0
    v_mfma_f32_16x16x32_bf16 v[116:119], v[52:55], v[36:39], v[116:119]
    ds_read_b128 v[20:23], v248 offset:2048
    v_mfma_f32_16x16x32_bf16 v[120:123], v[52:55], v[40:43], v[120:123]
    ds_read_b128 v[24:27], v248 offset:4096
    v_mfma_f32_16x16x32_bf16 v[124:127], v[52:55], v[44:47], v[124:127]
    ds_read_b128 v[28:31], v248 offset:6144
    ds_read_b64_tr_b16 v[52:53], v245 offset:0
    ds_read_b64_tr_b16 v[54:55], v245 offset:512
    v_mfma_f32_16x16x32_bf16 v[128:131], v[56:59], v[32:35], v[128:131]
    v_mfma_f32_16x16x32_bf16 v[132:135], v[56:59], v[36:39], v[132:135]
    v_mfma_f32_16x16x32_bf16 v[136:139], v[56:59], v[40:43], v[136:139]
    v_mfma_f32_16x16x32_bf16 v[140:143], v[56:59], v[44:47], v[140:143]
    ds_read_b64_tr_b16 v[56:57], v244 offset:8192
    ds_read_b64_tr_b16 v[58:59], v244 offset:8704
    v_mfma_f32_16x16x32_bf16 v[144:147], v[60:63], v[32:35], v[144:147]
    v_mfma_f32_16x16x32_bf16 v[148:151], v[60:63], v[36:39], v[148:151]
    v_mfma_f32_16x16x32_bf16 v[152:155], v[60:63], v[40:43], v[152:155]
    v_mfma_f32_16x16x32_bf16 v[156:159], v[60:63], v[44:47], v[156:159]
    ds_read_b64_tr_b16 v[60:61], v245 offset:8192
    ds_read_b64_tr_b16 v[62:63], v245 offset:8704
    v_mfma_f32_16x16x32_bf16 v[160:163], v[32:35], v[64:67], v[160:163]
    v_mfma_f32_16x16x32_bf16 v[164:167], v[36:39], v[64:67], v[164:167]
    v_mfma_f32_16x16x32_bf16 v[168:171], v[40:43], v[64:67], v[168:171]
    v_mfma_f32_16x16x32_bf16 v[172:175], v[44:47], v[64:67], v[172:175]
    ds_read_b128 v[64:67], v250 offset:0
    v_mfma_f32_16x16x32_bf16 v[176:179], v[32:35], v[68:71], v[176:179]
    v_mfma_f32_16x16x32_bf16 v[180:183], v[36:39], v[68:71], v[180:183]
    v_mfma_f32_16x16x32_bf16 v[184:187], v[40:43], v[68:71], v[184:187]
    v_mfma_f32_16x16x32_bf16 v[188:191], v[44:47], v[68:71], v[188:191]
    ds_read_b128 v[68:71], v250 offset:2048
    v_mfma_f32_16x16x32_bf16 v[192:195], v[32:35], v[72:75], v[192:195]
    v_mfma_f32_16x16x32_bf16 v[196:199], v[36:39], v[72:75], v[196:199]
    v_mfma_f32_16x16x32_bf16 v[200:203], v[40:43], v[72:75], v[200:203]
    v_mfma_f32_16x16x32_bf16 v[204:207], v[44:47], v[72:75], v[204:207]
    ds_read_b128 v[72:75], v250 offset:4096
    v_mfma_f32_16x16x32_bf16 v[208:211], v[32:35], v[76:79], v[208:211]
    v_mfma_f32_16x16x32_bf16 v[212:215], v[36:39], v[76:79], v[212:215]
    v_mfma_f32_16x16x32_bf16 v[216:219], v[40:43], v[76:79], v[216:219]
    v_mfma_f32_16x16x32_bf16 v[220:223], v[44:47], v[76:79], v[220:223]
    ds_read_b128 v[76:79], v250 offset:6144
    v_mfma_f32_16x16x32_bf16 v[224:227], v[32:35], v[80:83], v[224:227]
    v_mfma_f32_16x16x32_bf16 v[228:231], v[36:39], v[80:83], v[228:231]
    v_mfma_f32_16x16x32_bf16 v[232:235], v[40:43], v[80:83], v[232:235]
    v_mfma_f32_16x16x32_bf16 v[236:239], v[44:47], v[80:83], v[236:239]
    ds_read_b128 v[80:83], v250 offset:8192
    s_waitcnt lgkmcnt(11)
    v_mfma_f32_16x16x32_bf16 v[96:99], v[48:51], v[16:19], v[96:99]
    v_mfma_f32_16x16x32_bf16 v[100:103], v[48:51], v[20:23], v[100:103]
    v_mfma_f32_16x16x32_bf16 v[104:107], v[48:51], v[24:27], v[104:107]
    v_mfma_f32_16x16x32_bf16 v[108:111], v[48:51], v[28:31], v[108:111]
    ds_read_b64_tr_b16 v[48:49], v244 offset:4096
    ds_read_b64_tr_b16 v[50:51], v244 offset:4608
    s_waitcnt lgkmcnt(11)
    v_mfma_f32_16x16x32_bf16 v[112:115], v[52:55], v[16:19], v[112:115]
    ds_read_b128 v[32:35], v249 offset:0
    v_mfma_f32_16x16x32_bf16 v[116:119], v[52:55], v[20:23], v[116:119]
    ds_read_b128 v[36:39], v249 offset:2048
    v_mfma_f32_16x16x32_bf16 v[120:123], v[52:55], v[24:27], v[120:123]
    ds_read_b128 v[40:43], v249 offset:4096
    v_mfma_f32_16x16x32_bf16 v[124:127], v[52:55], v[28:31], v[124:127]
    ds_read_b128 v[44:47], v249 offset:6144
    ds_read_b64_tr_b16 v[52:53], v245 offset:4096
    ds_read_b64_tr_b16 v[54:55], v245 offset:4608
    s_waitcnt lgkmcnt(15)
    v_mfma_f32_16x16x32_bf16 v[128:131], v[56:59], v[16:19], v[128:131]
    v_mfma_f32_16x16x32_bf16 v[132:135], v[56:59], v[20:23], v[132:135]
    v_mfma_f32_16x16x32_bf16 v[136:139], v[56:59], v[24:27], v[136:139]
    v_mfma_f32_16x16x32_bf16 v[140:143], v[56:59], v[28:31], v[140:143]
    ds_read_b64_tr_b16 v[56:57], v244 offset:12288
    ds_read_b64_tr_b16 v[58:59], v244 offset:12800
    s_waitcnt lgkmcnt(15)
    v_mfma_f32_16x16x32_bf16 v[144:147], v[60:63], v[16:19], v[144:147]
    v_mfma_f32_16x16x32_bf16 v[148:151], v[60:63], v[20:23], v[148:151]
    v_mfma_f32_16x16x32_bf16 v[152:155], v[60:63], v[24:27], v[152:155]
    v_mfma_f32_16x16x32_bf16 v[156:159], v[60:63], v[28:31], v[156:159]
    ds_read_b64_tr_b16 v[60:61], v245 offset:12288
    ds_read_b64_tr_b16 v[62:63], v245 offset:12800
    s_waitcnt lgkmcnt(15)
    v_mfma_f32_16x16x32_bf16 v[160:163], v[16:19], v[64:67], v[160:163]
    v_mfma_f32_16x16x32_bf16 v[164:167], v[20:23], v[64:67], v[164:167]
    v_mfma_f32_16x16x32_bf16 v[168:171], v[24:27], v[64:67], v[168:171]
    v_mfma_f32_16x16x32_bf16 v[172:175], v[28:31], v[64:67], v[172:175]
    ds_read_b128 v[64:67], v251 offset:0
    s_waitcnt lgkmcnt(15)
    v_mfma_f32_16x16x32_bf16 v[176:179], v[16:19], v[68:71], v[176:179]
    v_mfma_f32_16x16x32_bf16 v[180:183], v[20:23], v[68:71], v[180:183]
    v_mfma_f32_16x16x32_bf16 v[184:187], v[24:27], v[68:71], v[184:187]
    v_mfma_f32_16x16x32_bf16 v[188:191], v[28:31], v[68:71], v[188:191]
    ds_read_b128 v[68:71], v251 offset:2048
    s_waitcnt lgkmcnt(15)
    v_mfma_f32_16x16x32_bf16 v[192:195], v[16:19], v[72:75], v[192:195]
    v_mfma_f32_16x16x32_bf16 v[196:199], v[20:23], v[72:75], v[196:199]
    v_mfma_f32_16x16x32_bf16 v[200:203], v[24:27], v[72:75], v[200:203]
    v_mfma_f32_16x16x32_bf16 v[204:207], v[28:31], v[72:75], v[204:207]
    ds_read_b128 v[72:75], v251 offset:4096
    s_waitcnt lgkmcnt(15)
    v_mfma_f32_16x16x32_bf16 v[208:211], v[16:19], v[76:79], v[208:211]
    v_mfma_f32_16x16x32_bf16 v[212:215], v[20:23], v[76:79], v[212:215]
    v_mfma_f32_16x16x32_bf16 v[216:219], v[24:27], v[76:79], v[216:219]
    v_mfma_f32_16x16x32_bf16 v[220:223], v[28:31], v[76:79], v[220:223]
    ds_read_b128 v[76:79], v251 offset:6144
    s_waitcnt lgkmcnt(15)
    v_mfma_f32_16x16x32_bf16 v[224:227], v[16:19], v[80:83], v[224:227]
    v_mfma_f32_16x16x32_bf16 v[228:231], v[20:23], v[80:83], v[228:231]
    v_mfma_f32_16x16x32_bf16 v[232:235], v[24:27], v[80:83], v[232:235]
    v_mfma_f32_16x16x32_bf16 v[236:239], v[28:31], v[80:83], v[236:239]
    ds_read_b128 v[80:83], v251 offset:8192
    s_waitcnt lgkmcnt(0)
    s_barrier
    v_mfma_f32_16x16x32_bf16 v[96:99], v[48:51], v[32:35], v[96:99]
    v_add_u32 v244, 0xd000, v4
    v_add_u32 v245, 0xd000, v5
    v_mfma_f32_16x16x32_bf16 v[100:103], v[48:51], v[36:39], v[100:103]
    v_add_u32 v248, 0xd000, v8
    v_add_u32 v250, 0xd000, v10
    v_mfma_f32_16x16x32_bf16 v[104:107], v[48:51], v[40:43], v[104:107]
    v_add_u32 v249, 0xd000, v9
    v_add_u32 v251, 0xd000, v11
    v_mfma_f32_16x16x32_bf16 v[108:111], v[48:51], v[44:47], v[108:111]
    ds_read_b64_tr_b16 v[48:49], v244 offset:0
    ds_read_b64_tr_b16 v[50:51], v244 offset:512
    v_mfma_f32_16x16x32_bf16 v[112:115], v[52:55], v[32:35], v[112:115]
    ds_read_b128 v[16:19], v248 offset:0
    v_mfma_f32_16x16x32_bf16 v[116:119], v[52:55], v[36:39], v[116:119]
    ds_read_b128 v[20:23], v248 offset:2048
    v_mfma_f32_16x16x32_bf16 v[120:123], v[52:55], v[40:43], v[120:123]
    ds_read_b128 v[24:27], v248 offset:4096
    v_mfma_f32_16x16x32_bf16 v[124:127], v[52:55], v[44:47], v[124:127]
    ds_read_b128 v[28:31], v248 offset:6144
    ds_read_b64_tr_b16 v[52:53], v245 offset:0
    ds_read_b64_tr_b16 v[54:55], v245 offset:512
    v_mfma_f32_16x16x32_bf16 v[128:131], v[56:59], v[32:35], v[128:131]
    v_mfma_f32_16x16x32_bf16 v[132:135], v[56:59], v[36:39], v[132:135]
    v_mfma_f32_16x16x32_bf16 v[136:139], v[56:59], v[40:43], v[136:139]
    v_mfma_f32_16x16x32_bf16 v[140:143], v[56:59], v[44:47], v[140:143]
    ds_read_b64_tr_b16 v[56:57], v244 offset:8192
    ds_read_b64_tr_b16 v[58:59], v244 offset:8704
    v_mfma_f32_16x16x32_bf16 v[144:147], v[60:63], v[32:35], v[144:147]
    v_mfma_f32_16x16x32_bf16 v[148:151], v[60:63], v[36:39], v[148:151]
    v_mfma_f32_16x16x32_bf16 v[152:155], v[60:63], v[40:43], v[152:155]
    v_mfma_f32_16x16x32_bf16 v[156:159], v[60:63], v[44:47], v[156:159]
    ds_read_b64_tr_b16 v[60:61], v245 offset:8192
    ds_read_b64_tr_b16 v[62:63], v245 offset:8704
    v_mfma_f32_16x16x32_bf16 v[160:163], v[32:35], v[64:67], v[160:163]
    v_mfma_f32_16x16x32_bf16 v[164:167], v[36:39], v[64:67], v[164:167]
    v_mfma_f32_16x16x32_bf16 v[168:171], v[40:43], v[64:67], v[168:171]
    v_mfma_f32_16x16x32_bf16 v[172:175], v[44:47], v[64:67], v[172:175]
    ds_read_b128 v[64:67], v250 offset:0
    v_mfma_f32_16x16x32_bf16 v[176:179], v[32:35], v[68:71], v[176:179]
    v_mfma_f32_16x16x32_bf16 v[180:183], v[36:39], v[68:71], v[180:183]
    v_mfma_f32_16x16x32_bf16 v[184:187], v[40:43], v[68:71], v[184:187]
    v_mfma_f32_16x16x32_bf16 v[188:191], v[44:47], v[68:71], v[188:191]
    ds_read_b128 v[68:71], v250 offset:2048
    v_mfma_f32_16x16x32_bf16 v[192:195], v[32:35], v[72:75], v[192:195]
    v_mfma_f32_16x16x32_bf16 v[196:199], v[36:39], v[72:75], v[196:199]
    v_mfma_f32_16x16x32_bf16 v[200:203], v[40:43], v[72:75], v[200:203]
    v_mfma_f32_16x16x32_bf16 v[204:207], v[44:47], v[72:75], v[204:207]
    ds_read_b128 v[72:75], v250 offset:4096
    v_mfma_f32_16x16x32_bf16 v[208:211], v[32:35], v[76:79], v[208:211]
    v_mfma_f32_16x16x32_bf16 v[212:215], v[36:39], v[76:79], v[212:215]
    v_mfma_f32_16x16x32_bf16 v[216:219], v[40:43], v[76:79], v[216:219]
    v_mfma_f32_16x16x32_bf16 v[220:223], v[44:47], v[76:79], v[220:223]
    ds_read_b128 v[76:79], v250 offset:6144
    v_mfma_f32_16x16x32_bf16 v[224:227], v[32:35], v[80:83], v[224:227]
    v_mfma_f32_16x16x32_bf16 v[228:231], v[36:39], v[80:83], v[228:231]
    v_mfma_f32_16x16x32_bf16 v[232:235], v[40:43], v[80:83], v[232:235]
    v_mfma_f32_16x16x32_bf16 v[236:239], v[44:47], v[80:83], v[236:239]
    ds_read_b128 v[80:83], v250 offset:8192
    s_waitcnt lgkmcnt(11)
    v_mfma_f32_16x16x32_bf16 v[96:99], v[48:51], v[16:19], v[96:99]
    v_mfma_f32_16x16x32_bf16 v[100:103], v[48:51], v[20:23], v[100:103]
    v_mfma_f32_16x16x32_bf16 v[104:107], v[48:51], v[24:27], v[104:107]
    v_mfma_f32_16x16x32_bf16 v[108:111], v[48:51], v[28:31], v[108:111]
    ds_read_b64_tr_b16 v[48:49], v244 offset:4096
    ds_read_b64_tr_b16 v[50:51], v244 offset:4608
    s_waitcnt lgkmcnt(11)
    v_mfma_f32_16x16x32_bf16 v[112:115], v[52:55], v[16:19], v[112:115]
    ds_read_b128 v[32:35], v249 offset:0
    v_mfma_f32_16x16x32_bf16 v[116:119], v[52:55], v[20:23], v[116:119]
    ds_read_b128 v[36:39], v249 offset:2048
    v_mfma_f32_16x16x32_bf16 v[120:123], v[52:55], v[24:27], v[120:123]
    ds_read_b128 v[40:43], v249 offset:4096
    v_mfma_f32_16x16x32_bf16 v[124:127], v[52:55], v[28:31], v[124:127]
    ds_read_b128 v[44:47], v249 offset:6144
    ds_read_b64_tr_b16 v[52:53], v245 offset:4096
    ds_read_b64_tr_b16 v[54:55], v245 offset:4608
    s_waitcnt lgkmcnt(15)
    v_mfma_f32_16x16x32_bf16 v[128:131], v[56:59], v[16:19], v[128:131]
    v_mfma_f32_16x16x32_bf16 v[132:135], v[56:59], v[20:23], v[132:135]
    v_mfma_f32_16x16x32_bf16 v[136:139], v[56:59], v[24:27], v[136:139]
    v_mfma_f32_16x16x32_bf16 v[140:143], v[56:59], v[28:31], v[140:143]
    ds_read_b64_tr_b16 v[56:57], v244 offset:12288
    ds_read_b64_tr_b16 v[58:59], v244 offset:12800
    s_waitcnt lgkmcnt(15)
    v_mfma_f32_16x16x32_bf16 v[144:147], v[60:63], v[16:19], v[144:147]
    v_mfma_f32_16x16x32_bf16 v[148:151], v[60:63], v[20:23], v[148:151]
    v_mfma_f32_16x16x32_bf16 v[152:155], v[60:63], v[24:27], v[152:155]
    v_mfma_f32_16x16x32_bf16 v[156:159], v[60:63], v[28:31], v[156:159]
    ds_read_b64_tr_b16 v[60:61], v245 offset:12288
    ds_read_b64_tr_b16 v[62:63], v245 offset:12800
    s_waitcnt lgkmcnt(15)
    v_mfma_f32_16x16x32_bf16 v[160:163], v[16:19], v[64:67], v[160:163]
    v_mfma_f32_16x16x32_bf16 v[164:167], v[20:23], v[64:67], v[164:167]
    v_mfma_f32_16x16x32_bf16 v[168:171], v[24:27], v[64:67], v[168:171]
    v_mfma_f32_16x16x32_bf16 v[172:175], v[28:31], v[64:67], v[172:175]
    ds_read_b128 v[64:67], v251 offset:0
    s_waitcnt lgkmcnt(15)
    v_mfma_f32_16x16x32_bf16 v[176:179], v[16:19], v[68:71], v[176:179]
    v_mfma_f32_16x16x32_bf16 v[180:183], v[20:23], v[68:71], v[180:183]
    v_mfma_f32_16x16x32_bf16 v[184:187], v[24:27], v[68:71], v[184:187]
    v_mfma_f32_16x16x32_bf16 v[188:191], v[28:31], v[68:71], v[188:191]
    ds_read_b128 v[68:71], v251 offset:2048
    s_waitcnt lgkmcnt(15)
    v_mfma_f32_16x16x32_bf16 v[192:195], v[16:19], v[72:75], v[192:195]
    v_mfma_f32_16x16x32_bf16 v[196:199], v[20:23], v[72:75], v[196:199]
    v_mfma_f32_16x16x32_bf16 v[200:203], v[24:27], v[72:75], v[200:203]
    v_mfma_f32_16x16x32_bf16 v[204:207], v[28:31], v[72:75], v[204:207]
    ds_read_b128 v[72:75], v251 offset:4096
    s_waitcnt lgkmcnt(15)
    v_mfma_f32_16x16x32_bf16 v[208:211], v[16:19], v[76:79], v[208:211]
    v_mfma_f32_16x16x32_bf16 v[212:215], v[20:23], v[76:79], v[212:215]
    v_mfma_f32_16x16x32_bf16 v[216:219], v[24:27], v[76:79], v[216:219]
    v_mfma_f32_16x16x32_bf16 v[220:223], v[28:31], v[76:79], v[220:223]
    ds_read_b128 v[76:79], v251 offset:6144
    s_waitcnt lgkmcnt(15)
    v_mfma_f32_16x16x32_bf16 v[224:227], v[16:19], v[80:83], v[224:227]
    v_mfma_f32_16x16x32_bf16 v[228:231], v[20:23], v[80:83], v[228:231]
    v_mfma_f32_16x16x32_bf16 v[232:235], v[24:27], v[80:83], v[232:235]
    v_mfma_f32_16x16x32_bf16 v[236:239], v[28:31], v[80:83], v[236:239]
    ds_read_b128 v[80:83], v251 offset:8192
    s_waitcnt lgkmcnt(0)
    s_barrier
    v_mfma_f32_16x16x32_bf16 v[96:99], v[48:51], v[32:35], v[96:99]
    v_add_u32 v244, 0x1a000, v4
    v_add_u32 v245, 0x1a000, v5
    v_mfma_f32_16x16x32_bf16 v[100:103], v[48:51], v[36:39], v[100:103]
    v_add_u32 v248, 0x1a000, v8
    v_add_u32 v250, 0x1a000, v10
    v_mfma_f32_16x16x32_bf16 v[104:107], v[48:51], v[40:43], v[104:107]
    v_add_u32 v249, 0x1a000, v9
    v_add_u32 v251, 0x1a000, v11
    v_mfma_f32_16x16x32_bf16 v[108:111], v[48:51], v[44:47], v[108:111]
    ds_read_b64_tr_b16 v[48:49], v244 offset:0
    ds_read_b64_tr_b16 v[50:51], v244 offset:512
    v_mfma_f32_16x16x32_bf16 v[112:115], v[52:55], v[32:35], v[112:115]
    ds_read_b128 v[16:19], v248 offset:0
    v_mfma_f32_16x16x32_bf16 v[116:119], v[52:55], v[36:39], v[116:119]
    ds_read_b128 v[20:23], v248 offset:2048
    v_mfma_f32_16x16x32_bf16 v[120:123], v[52:55], v[40:43], v[120:123]
    ds_read_b128 v[24:27], v248 offset:4096
    v_mfma_f32_16x16x32_bf16 v[124:127], v[52:55], v[44:47], v[124:127]
    ds_read_b128 v[28:31], v248 offset:6144
    ds_read_b64_tr_b16 v[52:53], v245 offset:0
    ds_read_b64_tr_b16 v[54:55], v245 offset:512
    v_mfma_f32_16x16x32_bf16 v[128:131], v[56:59], v[32:35], v[128:131]
    v_mfma_f32_16x16x32_bf16 v[132:135], v[56:59], v[36:39], v[132:135]
    v_mfma_f32_16x16x32_bf16 v[136:139], v[56:59], v[40:43], v[136:139]
    v_mfma_f32_16x16x32_bf16 v[140:143], v[56:59], v[44:47], v[140:143]
    ds_read_b64_tr_b16 v[56:57], v244 offset:8192
    ds_read_b64_tr_b16 v[58:59], v244 offset:8704
    v_mfma_f32_16x16x32_bf16 v[144:147], v[60:63], v[32:35], v[144:147]
    v_mfma_f32_16x16x32_bf16 v[148:151], v[60:63], v[36:39], v[148:151]
    v_mfma_f32_16x16x32_bf16 v[152:155], v[60:63], v[40:43], v[152:155]
    v_mfma_f32_16x16x32_bf16 v[156:159], v[60:63], v[44:47], v[156:159]
    ds_read_b64_tr_b16 v[60:61], v245 offset:8192
    ds_read_b64_tr_b16 v[62:63], v245 offset:8704
    v_mfma_f32_16x16x32_bf16 v[160:163], v[32:35], v[64:67], v[160:163]
    v_mfma_f32_16x16x32_bf16 v[164:167], v[36:39], v[64:67], v[164:167]
    v_mfma_f32_16x16x32_bf16 v[168:171], v[40:43], v[64:67], v[168:171]
    v_mfma_f32_16x16x32_bf16 v[172:175], v[44:47], v[64:67], v[172:175]
    ds_read_b128 v[64:67], v250 offset:0
    v_mfma_f32_16x16x32_bf16 v[176:179], v[32:35], v[68:71], v[176:179]
    v_mfma_f32_16x16x32_bf16 v[180:183], v[36:39], v[68:71], v[180:183]
    v_mfma_f32_16x16x32_bf16 v[184:187], v[40:43], v[68:71], v[184:187]
    v_mfma_f32_16x16x32_bf16 v[188:191], v[44:47], v[68:71], v[188:191]
    ds_read_b128 v[68:71], v250 offset:2048
    v_mfma_f32_16x16x32_bf16 v[192:195], v[32:35], v[72:75], v[192:195]
    v_mfma_f32_16x16x32_bf16 v[196:199], v[36:39], v[72:75], v[196:199]
    v_mfma_f32_16x16x32_bf16 v[200:203], v[40:43], v[72:75], v[200:203]
    v_mfma_f32_16x16x32_bf16 v[204:207], v[44:47], v[72:75], v[204:207]
    ds_read_b128 v[72:75], v250 offset:4096
    v_mfma_f32_16x16x32_bf16 v[208:211], v[32:35], v[76:79], v[208:211]
    v_mfma_f32_16x16x32_bf16 v[212:215], v[36:39], v[76:79], v[212:215]
    v_mfma_f32_16x16x32_bf16 v[216:219], v[40:43], v[76:79], v[216:219]
    v_mfma_f32_16x16x32_bf16 v[220:223], v[44:47], v[76:79], v[220:223]
    ds_read_b128 v[76:79], v250 offset:6144
    v_mfma_f32_16x16x32_bf16 v[224:227], v[32:35], v[80:83], v[224:227]
    v_mfma_f32_16x16x32_bf16 v[228:231], v[36:39], v[80:83], v[228:231]
    v_mfma_f32_16x16x32_bf16 v[232:235], v[40:43], v[80:83], v[232:235]
    v_mfma_f32_16x16x32_bf16 v[236:239], v[44:47], v[80:83], v[236:239]
    ds_read_b128 v[80:83], v250 offset:8192
    s_waitcnt lgkmcnt(11)
    v_mfma_f32_16x16x32_bf16 v[96:99], v[48:51], v[16:19], v[96:99]
    v_mfma_f32_16x16x32_bf16 v[100:103], v[48:51], v[20:23], v[100:103]
    v_mfma_f32_16x16x32_bf16 v[104:107], v[48:51], v[24:27], v[104:107]
    v_mfma_f32_16x16x32_bf16 v[108:111], v[48:51], v[28:31], v[108:111]
    ds_read_b64_tr_b16 v[48:49], v244 offset:4096
    ds_read_b64_tr_b16 v[50:51], v244 offset:4608
    s_waitcnt lgkmcnt(11)
    v_mfma_f32_16x16x32_bf16 v[112:115], v[52:55], v[16:19], v[112:115]
    ds_read_b128 v[32:35], v249 offset:0
    v_mfma_f32_16x16x32_bf16 v[116:119], v[52:55], v[20:23], v[116:119]
    ds_read_b128 v[36:39], v249 offset:2048
    v_mfma_f32_16x16x32_bf16 v[120:123], v[52:55], v[24:27], v[120:123]
    ds_read_b128 v[40:43], v249 offset:4096
    v_mfma_f32_16x16x32_bf16 v[124:127], v[52:55], v[28:31], v[124:127]
    ds_read_b128 v[44:47], v249 offset:6144
    ds_read_b64_tr_b16 v[52:53], v245 offset:4096
    ds_read_b64_tr_b16 v[54:55], v245 offset:4608
    s_waitcnt lgkmcnt(15)
    v_mfma_f32_16x16x32_bf16 v[128:131], v[56:59], v[16:19], v[128:131]
    v_mfma_f32_16x16x32_bf16 v[132:135], v[56:59], v[20:23], v[132:135]
    v_mfma_f32_16x16x32_bf16 v[136:139], v[56:59], v[24:27], v[136:139]
    v_mfma_f32_16x16x32_bf16 v[140:143], v[56:59], v[28:31], v[140:143]
    ds_read_b64_tr_b16 v[56:57], v244 offset:12288
    ds_read_b64_tr_b16 v[58:59], v244 offset:12800
    s_waitcnt lgkmcnt(15)
    v_mfma_f32_16x16x32_bf16 v[144:147], v[60:63], v[16:19], v[144:147]
    v_mfma_f32_16x16x32_bf16 v[148:151], v[60:63], v[20:23], v[148:151]
    v_mfma_f32_16x16x32_bf16 v[152:155], v[60:63], v[24:27], v[152:155]
    v_mfma_f32_16x16x32_bf16 v[156:159], v[60:63], v[28:31], v[156:159]
    ds_read_b64_tr_b16 v[60:61], v245 offset:12288
    ds_read_b64_tr_b16 v[62:63], v245 offset:12800
    s_waitcnt lgkmcnt(15)
    v_mfma_f32_16x16x32_bf16 v[160:163], v[16:19], v[64:67], v[160:163]
    v_mfma_f32_16x16x32_bf16 v[164:167], v[20:23], v[64:67], v[164:167]
    v_mfma_f32_16x16x32_bf16 v[168:171], v[24:27], v[64:67], v[168:171]
    v_mfma_f32_16x16x32_bf16 v[172:175], v[28:31], v[64:67], v[172:175]
    ds_read_b128 v[64:67], v251 offset:0
    s_waitcnt lgkmcnt(15)
    v_mfma_f32_16x16x32_bf16 v[176:179], v[16:19], v[68:71], v[176:179]
    v_mfma_f32_16x16x32_bf16 v[180:183], v[20:23], v[68:71], v[180:183]
    v_mfma_f32_16x16x32_bf16 v[184:187], v[24:27], v[68:71], v[184:187]
    v_mfma_f32_16x16x32_bf16 v[188:191], v[28:31], v[68:71], v[188:191]
    ds_read_b128 v[68:71], v251 offset:2048
    s_waitcnt lgkmcnt(15)
    v_mfma_f32_16x16x32_bf16 v[192:195], v[16:19], v[72:75], v[192:195]
    v_mfma_f32_16x16x32_bf16 v[196:199], v[20:23], v[72:75], v[196:199]
    v_mfma_f32_16x16x32_bf16 v[200:203], v[24:27], v[72:75], v[200:203]
    v_mfma_f32_16x16x32_bf16 v[204:207], v[28:31], v[72:75], v[204:207]
    ds_read_b128 v[72:75], v251 offset:4096
    s_waitcnt lgkmcnt(15)
    v_mfma_f32_16x16x32_bf16 v[208:211], v[16:19], v[76:79], v[208:211]
    v_mfma_f32_16x16x32_bf16 v[212:215], v[20:23], v[76:79], v[212:215]
    v_mfma_f32_16x16x32_bf16 v[216:219], v[24:27], v[76:79], v[216:219]
    v_mfma_f32_16x16x32_bf16 v[220:223], v[28:31], v[76:79], v[220:223]
    ds_read_b128 v[76:79], v251 offset:6144
    s_waitcnt lgkmcnt(15)
    v_mfma_f32_16x16x32_bf16 v[224:227], v[16:19], v[80:83], v[224:227]
    v_mfma_f32_16x16x32_bf16 v[228:231], v[20:23], v[80:83], v[228:231]
    v_mfma_f32_16x16x32_bf16 v[232:235], v[24:27], v[80:83], v[232:235]
    v_mfma_f32_16x16x32_bf16 v[236:239], v[28:31], v[80:83], v[236:239]
    ds_read_b128 v[80:83], v251 offset:8192
    s_waitcnt lgkmcnt(0)
    s_barrier
    v_mfma_f32_16x16x32_bf16 v[96:99], v[48:51], v[32:35], v[96:99]
    v_add_u32 v244, 0x0, v4
    v_add_u32 v245, 0x0, v5
    v_mfma_f32_16x16x32_bf16 v[100:103], v[48:51], v[36:39], v[100:103]
    v_add_u32 v248, 0x0, v8
    v_add_u32 v250, 0x0, v10
    v_mfma_f32_16x16x32_bf16 v[104:107], v[48:51], v[40:43], v[104:107]
    v_add_u32 v249, 0x0, v9
    v_add_u32 v251, 0x0, v11
    v_mfma_f32_16x16x32_bf16 v[108:111], v[48:51], v[44:47], v[108:111]
    ds_read_b64_tr_b16 v[48:49], v244 offset:0
    ds_read_b64_tr_b16 v[50:51], v244 offset:512
    v_mfma_f32_16x16x32_bf16 v[112:115], v[52:55], v[32:35], v[112:115]
    ds_read_b128 v[16:19], v248 offset:0
    v_mfma_f32_16x16x32_bf16 v[116:119], v[52:55], v[36:39], v[116:119]
    ds_read_b128 v[20:23], v248 offset:2048
    v_mfma_f32_16x16x32_bf16 v[120:123], v[52:55], v[40:43], v[120:123]
    ds_read_b128 v[24:27], v248 offset:4096
    v_mfma_f32_16x16x32_bf16 v[124:127], v[52:55], v[44:47], v[124:127]
    ds_read_b128 v[28:31], v248 offset:6144
    ds_read_b64_tr_b16 v[52:53], v245 offset:0
    ds_read_b64_tr_b16 v[54:55], v245 offset:512
    v_mfma_f32_16x16x32_bf16 v[128:131], v[56:59], v[32:35], v[128:131]
    v_mfma_f32_16x16x32_bf16 v[132:135], v[56:59], v[36:39], v[132:135]
    v_mfma_f32_16x16x32_bf16 v[136:139], v[56:59], v[40:43], v[136:139]
    v_mfma_f32_16x16x32_bf16 v[140:143], v[56:59], v[44:47], v[140:143]
    ds_read_b64_tr_b16 v[56:57], v244 offset:8192
    ds_read_b64_tr_b16 v[58:59], v244 offset:8704
    v_mfma_f32_16x16x32_bf16 v[144:147], v[60:63], v[32:35], v[144:147]
    v_mfma_f32_16x16x32_bf16 v[148:151], v[60:63], v[36:39], v[148:151]
    v_mfma_f32_16x16x32_bf16 v[152:155], v[60:63], v[40:43], v[152:155]
    v_mfma_f32_16x16x32_bf16 v[156:159], v[60:63], v[44:47], v[156:159]
    ds_read_b64_tr_b16 v[60:61], v245 offset:8192
    ds_read_b64_tr_b16 v[62:63], v245 offset:8704
    v_mfma_f32_16x16x32_bf16 v[160:163], v[32:35], v[64:67], v[160:163]
    v_mfma_f32_16x16x32_bf16 v[164:167], v[36:39], v[64:67], v[164:167]
    v_mfma_f32_16x16x32_bf16 v[168:171], v[40:43], v[64:67], v[168:171]
    v_mfma_f32_16x16x32_bf16 v[172:175], v[44:47], v[64:67], v[172:175]
    ds_read_b128 v[64:67], v250 offset:0
    v_mfma_f32_16x16x32_bf16 v[176:179], v[32:35], v[68:71], v[176:179]
    v_mfma_f32_16x16x32_bf16 v[180:183], v[36:39], v[68:71], v[180:183]
    v_mfma_f32_16x16x32_bf16 v[184:187], v[40:43], v[68:71], v[184:187]
    v_mfma_f32_16x16x32_bf16 v[188:191], v[44:47], v[68:71], v[188:191]
    ds_read_b128 v[68:71], v250 offset:2048
    v_mfma_f32_16x16x32_bf16 v[192:195], v[32:35], v[72:75], v[192:195]
    v_mfma_f32_16x16x32_bf16 v[196:199], v[36:39], v[72:75], v[196:199]
    v_mfma_f32_16x16x32_bf16 v[200:203], v[40:43], v[72:75], v[200:203]
    v_mfma_f32_16x16x32_bf16 v[204:207], v[44:47], v[72:75], v[204:207]
    ds_read_b128 v[72:75], v250 offset:4096
    v_mfma_f32_16x16x32_bf16 v[208:211], v[32:35], v[76:79], v[208:211]
    v_mfma_f32_16x16x32_bf16 v[212:215], v[36:39], v[76:79], v[212:215]
    v_mfma_f32_16x16x32_bf16 v[216:219], v[40:43], v[76:79], v[216:219]
    v_mfma_f32_16x16x32_bf16 v[220:223], v[44:47], v[76:79], v[220:223]
    ds_read_b128 v[76:79], v250 offset:6144
    v_mfma_f32_16x16x32_bf16 v[224:227], v[32:35], v[80:83], v[224:227]
    v_mfma_f32_16x16x32_bf16 v[228:231], v[36:39], v[80:83], v[228:231]
    v_mfma_f32_16x16x32_bf16 v[232:235], v[40:43], v[80:83], v[232:235]
    v_mfma_f32_16x16x32_bf16 v[236:239], v[44:47], v[80:83], v[236:239]
    ds_read_b128 v[80:83], v250 offset:8192
    s_waitcnt lgkmcnt(11)
    v_mfma_f32_16x16x32_bf16 v[96:99], v[48:51], v[16:19], v[96:99]
    v_mfma_f32_16x16x32_bf16 v[100:103], v[48:51], v[20:23], v[100:103]
    v_mfma_f32_16x16x32_bf16 v[104:107], v[48:51], v[24:27], v[104:107]
    v_mfma_f32_16x16x32_bf16 v[108:111], v[48:51], v[28:31], v[108:111]
    ds_read_b64_tr_b16 v[48:49], v244 offset:4096
    ds_read_b64_tr_b16 v[50:51], v244 offset:4608
    s_waitcnt lgkmcnt(11)
    v_mfma_f32_16x16x32_bf16 v[112:115], v[52:55], v[16:19], v[112:115]
    ds_read_b128 v[32:35], v249 offset:0
    v_mfma_f32_16x16x32_bf16 v[116:119], v[52:55], v[20:23], v[116:119]
    ds_read_b128 v[36:39], v249 offset:2048
    v_mfma_f32_16x16x32_bf16 v[120:123], v[52:55], v[24:27], v[120:123]
    ds_read_b128 v[40:43], v249 offset:4096
    v_mfma_f32_16x16x32_bf16 v[124:127], v[52:55], v[28:31], v[124:127]
    ds_read_b128 v[44:47], v249 offset:6144
    ds_read_b64_tr_b16 v[52:53], v245 offset:4096
    ds_read_b64_tr_b16 v[54:55], v245 offset:4608
    s_waitcnt lgkmcnt(15)
    v_mfma_f32_16x16x32_bf16 v[128:131], v[56:59], v[16:19], v[128:131]
    v_mfma_f32_16x16x32_bf16 v[132:135], v[56:59], v[20:23], v[132:135]
    v_mfma_f32_16x16x32_bf16 v[136:139], v[56:59], v[24:27], v[136:139]
    v_mfma_f32_16x16x32_bf16 v[140:143], v[56:59], v[28:31], v[140:143]
    ds_read_b64_tr_b16 v[56:57], v244 offset:12288
    ds_read_b64_tr_b16 v[58:59], v244 offset:12800
    s_waitcnt lgkmcnt(15)
    v_mfma_f32_16x16x32_bf16 v[144:147], v[60:63], v[16:19], v[144:147]
    v_mfma_f32_16x16x32_bf16 v[148:151], v[60:63], v[20:23], v[148:151]
    v_mfma_f32_16x16x32_bf16 v[152:155], v[60:63], v[24:27], v[152:155]
    v_mfma_f32_16x16x32_bf16 v[156:159], v[60:63], v[28:31], v[156:159]
    ds_read_b64_tr_b16 v[60:61], v245 offset:12288
    ds_read_b64_tr_b16 v[62:63], v245 offset:12800
    s_waitcnt lgkmcnt(15)
    v_mfma_f32_16x16x32_bf16 v[160:163], v[16:19], v[64:67], v[160:163]
    v_mfma_f32_16x16x32_bf16 v[164:167], v[20:23], v[64:67], v[164:167]
    v_mfma_f32_16x16x32_bf16 v[168:171], v[24:27], v[64:67], v[168:171]
    v_mfma_f32_16x16x32_bf16 v[172:175], v[28:31], v[64:67], v[172:175]
    ds_read_b128 v[64:67], v251 offset:0
    s_waitcnt lgkmcnt(15)
    v_mfma_f32_16x16x32_bf16 v[176:179], v[16:19], v[68:71], v[176:179]
    v_mfma_f32_16x16x32_bf16 v[180:183], v[20:23], v[68:71], v[180:183]
    v_mfma_f32_16x16x32_bf16 v[184:187], v[24:27], v[68:71], v[184:187]
    v_mfma_f32_16x16x32_bf16 v[188:191], v[28:31], v[68:71], v[188:191]
    ds_read_b128 v[68:71], v251 offset:2048
    s_waitcnt lgkmcnt(15)
    v_mfma_f32_16x16x32_bf16 v[192:195], v[16:19], v[72:75], v[192:195]
    v_mfma_f32_16x16x32_bf16 v[196:199], v[20:23], v[72:75], v[196:199]
    v_mfma_f32_16x16x32_bf16 v[200:203], v[24:27], v[72:75], v[200:203]
    v_mfma_f32_16x16x32_bf16 v[204:207], v[28:31], v[72:75], v[204:207]
    ds_read_b128 v[72:75], v251 offset:4096
    s_waitcnt lgkmcnt(15)
    v_mfma_f32_16x16x32_bf16 v[208:211], v[16:19], v[76:79], v[208:211]
    v_mfma_f32_16x16x32_bf16 v[212:215], v[20:23], v[76:79], v[212:215]
    v_mfma_f32_16x16x32_bf16 v[216:219], v[24:27], v[76:79], v[216:219]
    v_mfma_f32_16x16x32_bf16 v[220:223], v[28:31], v[76:79], v[220:223]
    ds_read_b128 v[76:79], v251 offset:6144
    s_waitcnt lgkmcnt(15)
    v_mfma_f32_16x16x32_bf16 v[224:227], v[16:19], v[80:83], v[224:227]
    v_mfma_f32_16x16x32_bf16 v[228:231], v[20:23], v[80:83], v[228:231]
    v_mfma_f32_16x16x32_bf16 v[232:235], v[24:27], v[80:83], v[232:235]
    v_mfma_f32_16x16x32_bf16 v[236:239], v[28:31], v[80:83], v[236:239]
    ds_read_b128 v[80:83], v251 offset:8192
    s_waitcnt lgkmcnt(0)
    s_barrier
    v_mfma_f32_16x16x32_bf16 v[96:99], v[48:51], v[32:35], v[96:99]
    v_add_u32 v244, 0xd000, v4
    v_add_u32 v245, 0xd000, v5
    v_mfma_f32_16x16x32_bf16 v[100:103], v[48:51], v[36:39], v[100:103]
    v_add_u32 v248, 0xd000, v8
    v_add_u32 v250, 0xd000, v10
    v_mfma_f32_16x16x32_bf16 v[104:107], v[48:51], v[40:43], v[104:107]
    v_add_u32 v249, 0xd000, v9
    v_add_u32 v251, 0xd000, v11
    v_mfma_f32_16x16x32_bf16 v[108:111], v[48:51], v[44:47], v[108:111]
    ds_read_b64_tr_b16 v[48:49], v244 offset:0
    ds_read_b64_tr_b16 v[50:51], v244 offset:512
    v_mfma_f32_16x16x32_bf16 v[112:115], v[52:55], v[32:35], v[112:115]
    ds_read_b128 v[16:19], v248 offset:0
    v_mfma_f32_16x16x32_bf16 v[116:119], v[52:55], v[36:39], v[116:119]
    ds_read_b128 v[20:23], v248 offset:2048
    v_mfma_f32_16x16x32_bf16 v[120:123], v[52:55], v[40:43], v[120:123]
    ds_read_b128 v[24:27], v248 offset:4096
    v_mfma_f32_16x16x32_bf16 v[124:127], v[52:55], v[44:47], v[124:127]
    ds_read_b128 v[28:31], v248 offset:6144
    ds_read_b64_tr_b16 v[52:53], v245 offset:0
    ds_read_b64_tr_b16 v[54:55], v245 offset:512
    v_mfma_f32_16x16x32_bf16 v[128:131], v[56:59], v[32:35], v[128:131]
    v_mfma_f32_16x16x32_bf16 v[132:135], v[56:59], v[36:39], v[132:135]
    v_mfma_f32_16x16x32_bf16 v[136:139], v[56:59], v[40:43], v[136:139]
    v_mfma_f32_16x16x32_bf16 v[140:143], v[56:59], v[44:47], v[140:143]
    ds_read_b64_tr_b16 v[56:57], v244 offset:8192
    ds_read_b64_tr_b16 v[58:59], v244 offset:8704
    v_mfma_f32_16x16x32_bf16 v[144:147], v[60:63], v[32:35], v[144:147]
    v_mfma_f32_16x16x32_bf16 v[148:151], v[60:63], v[36:39], v[148:151]
    v_mfma_f32_16x16x32_bf16 v[152:155], v[60:63], v[40:43], v[152:155]
    v_mfma_f32_16x16x32_bf16 v[156:159], v[60:63], v[44:47], v[156:159]
    ds_read_b64_tr_b16 v[60:61], v245 offset:8192
    ds_read_b64_tr_b16 v[62:63], v245 offset:8704
    v_mfma_f32_16x16x32_bf16 v[160:163], v[32:35], v[64:67], v[160:163]
    v_mfma_f32_16x16x32_bf16 v[164:167], v[36:39], v[64:67], v[164:167]
    v_mfma_f32_16x16x32_bf16 v[168:171], v[40:43], v[64:67], v[168:171]
    v_mfma_f32_16x16x32_bf16 v[172:175], v[44:47], v[64:67], v[172:175]
    ds_read_b128 v[64:67], v250 offset:0
    v_mfma_f32_16x16x32_bf16 v[176:179], v[32:35], v[68:71], v[176:179]
    v_mfma_f32_16x16x32_bf16 v[180:183], v[36:39], v[68:71], v[180:183]
    v_mfma_f32_16x16x32_bf16 v[184:187], v[40:43], v[68:71], v[184:187]
    v_mfma_f32_16x16x32_bf16 v[188:191], v[44:47], v[68:71], v[188:191]
    ds_read_b128 v[68:71], v250 offset:2048
    v_mfma_f32_16x16x32_bf16 v[192:195], v[32:35], v[72:75], v[192:195]
    v_mfma_f32_16x16x32_bf16 v[196:199], v[36:39], v[72:75], v[196:199]
    v_mfma_f32_16x16x32_bf16 v[200:203], v[40:43], v[72:75], v[200:203]
    v_mfma_f32_16x16x32_bf16 v[204:207], v[44:47], v[72:75], v[204:207]
    ds_read_b128 v[72:75], v250 offset:4096
    v_mfma_f32_16x16x32_bf16 v[208:211], v[32:35], v[76:79], v[208:211]
    v_mfma_f32_16x16x32_bf16 v[212:215], v[36:39], v[76:79], v[212:215]
    v_mfma_f32_16x16x32_bf16 v[216:219], v[40:43], v[76:79], v[216:219]
    v_mfma_f32_16x16x32_bf16 v[220:223], v[44:47], v[76:79], v[220:223]
    ds_read_b128 v[76:79], v250 offset:6144
    v_mfma_f32_16x16x32_bf16 v[224:227], v[32:35], v[80:83], v[224:227]
    v_mfma_f32_16x16x32_bf16 v[228:231], v[36:39], v[80:83], v[228:231]
    v_mfma_f32_16x16x32_bf16 v[232:235], v[40:43], v[80:83], v[232:235]
    v_mfma_f32_16x16x32_bf16 v[236:239], v[44:47], v[80:83], v[236:239]
    ds_read_b128 v[80:83], v250 offset:8192
    s_waitcnt lgkmcnt(11)
    v_mfma_f32_16x16x32_bf16 v[96:99], v[48:51], v[16:19], v[96:99]
    v_mfma_f32_16x16x32_bf16 v[100:103], v[48:51], v[20:23], v[100:103]
    v_mfma_f32_16x16x32_bf16 v[104:107], v[48:51], v[24:27], v[104:107]
    v_mfma_f32_16x16x32_bf16 v[108:111], v[48:51], v[28:31], v[108:111]
    ds_read_b64_tr_b16 v[48:49], v244 offset:4096
    ds_read_b64_tr_b16 v[50:51], v244 offset:4608
    s_waitcnt lgkmcnt(11)
    v_mfma_f32_16x16x32_bf16 v[112:115], v[52:55], v[16:19], v[112:115]
    ds_read_b128 v[32:35], v249 offset:0
    v_mfma_f32_16x16x32_bf16 v[116:119], v[52:55], v[20:23], v[116:119]
    ds_read_b128 v[36:39], v249 offset:2048
    v_mfma_f32_16x16x32_bf16 v[120:123], v[52:55], v[24:27], v[120:123]
    ds_read_b128 v[40:43], v249 offset:4096
    v_mfma_f32_16x16x32_bf16 v[124:127], v[52:55], v[28:31], v[124:127]
    ds_read_b128 v[44:47], v249 offset:6144
    ds_read_b64_tr_b16 v[52:53], v245 offset:4096
    ds_read_b64_tr_b16 v[54:55], v245 offset:4608
    s_waitcnt lgkmcnt(15)
    v_mfma_f32_16x16x32_bf16 v[128:131], v[56:59], v[16:19], v[128:131]
    v_mfma_f32_16x16x32_bf16 v[132:135], v[56:59], v[20:23], v[132:135]
    v_mfma_f32_16x16x32_bf16 v[136:139], v[56:59], v[24:27], v[136:139]
    v_mfma_f32_16x16x32_bf16 v[140:143], v[56:59], v[28:31], v[140:143]
    ds_read_b64_tr_b16 v[56:57], v244 offset:12288
    ds_read_b64_tr_b16 v[58:59], v244 offset:12800
    s_waitcnt lgkmcnt(15)
    v_mfma_f32_16x16x32_bf16 v[144:147], v[60:63], v[16:19], v[144:147]
    v_mfma_f32_16x16x32_bf16 v[148:151], v[60:63], v[20:23], v[148:151]
    v_mfma_f32_16x16x32_bf16 v[152:155], v[60:63], v[24:27], v[152:155]
    v_mfma_f32_16x16x32_bf16 v[156:159], v[60:63], v[28:31], v[156:159]
    ds_read_b64_tr_b16 v[60:61], v245 offset:12288
    ds_read_b64_tr_b16 v[62:63], v245 offset:12800
    s_waitcnt lgkmcnt(15)
    v_mfma_f32_16x16x32_bf16 v[160:163], v[16:19], v[64:67], v[160:163]
    v_mfma_f32_16x16x32_bf16 v[164:167], v[20:23], v[64:67], v[164:167]
    v_mfma_f32_16x16x32_bf16 v[168:171], v[24:27], v[64:67], v[168:171]
    v_mfma_f32_16x16x32_bf16 v[172:175], v[28:31], v[64:67], v[172:175]
    ds_read_b128 v[64:67], v251 offset:0
    s_waitcnt lgkmcnt(15)
    v_mfma_f32_16x16x32_bf16 v[176:179], v[16:19], v[68:71], v[176:179]
    v_mfma_f32_16x16x32_bf16 v[180:183], v[20:23], v[68:71], v[180:183]
    v_mfma_f32_16x16x32_bf16 v[184:187], v[24:27], v[68:71], v[184:187]
    v_mfma_f32_16x16x32_bf16 v[188:191], v[28:31], v[68:71], v[188:191]
    ds_read_b128 v[68:71], v251 offset:2048
    s_waitcnt lgkmcnt(15)
    v_mfma_f32_16x16x32_bf16 v[192:195], v[16:19], v[72:75], v[192:195]
    v_mfma_f32_16x16x32_bf16 v[196:199], v[20:23], v[72:75], v[196:199]
    v_mfma_f32_16x16x32_bf16 v[200:203], v[24:27], v[72:75], v[200:203]
    v_mfma_f32_16x16x32_bf16 v[204:207], v[28:31], v[72:75], v[204:207]
    ds_read_b128 v[72:75], v251 offset:4096
    s_waitcnt lgkmcnt(15)
    v_mfma_f32_16x16x32_bf16 v[208:211], v[16:19], v[76:79], v[208:211]
    v_mfma_f32_16x16x32_bf16 v[212:215], v[20:23], v[76:79], v[212:215]
    v_mfma_f32_16x16x32_bf16 v[216:219], v[24:27], v[76:79], v[216:219]
    v_mfma_f32_16x16x32_bf16 v[220:223], v[28:31], v[76:79], v[220:223]
    ds_read_b128 v[76:79], v251 offset:6144
    s_waitcnt lgkmcnt(15)
    v_mfma_f32_16x16x32_bf16 v[224:227], v[16:19], v[80:83], v[224:227]
    v_mfma_f32_16x16x32_bf16 v[228:231], v[20:23], v[80:83], v[228:231]
    v_mfma_f32_16x16x32_bf16 v[232:235], v[24:27], v[80:83], v[232:235]
    v_mfma_f32_16x16x32_bf16 v[236:239], v[28:31], v[80:83], v[236:239]
    ds_read_b128 v[80:83], v251 offset:8192
    s_waitcnt lgkmcnt(11)
    v_mfma_f32_16x16x32_bf16 v[96:99], v[48:51], v[32:35], v[96:99]
    v_mfma_f32_16x16x32_bf16 v[100:103], v[48:51], v[36:39], v[100:103]
    v_mfma_f32_16x16x32_bf16 v[104:107], v[48:51], v[40:43], v[104:107]
    v_mfma_f32_16x16x32_bf16 v[108:111], v[48:51], v[44:47], v[108:111]
    s_waitcnt lgkmcnt(9)
    v_mfma_f32_16x16x32_bf16 v[112:115], v[52:55], v[32:35], v[112:115]
    v_mfma_f32_16x16x32_bf16 v[116:119], v[52:55], v[36:39], v[116:119]
    v_mfma_f32_16x16x32_bf16 v[120:123], v[52:55], v[40:43], v[120:123]
    v_mfma_f32_16x16x32_bf16 v[124:127], v[52:55], v[44:47], v[124:127]
    s_waitcnt lgkmcnt(7)
    v_mfma_f32_16x16x32_bf16 v[128:131], v[56:59], v[32:35], v[128:131]
    v_mfma_f32_16x16x32_bf16 v[132:135], v[56:59], v[36:39], v[132:135]
    v_mfma_f32_16x16x32_bf16 v[136:139], v[56:59], v[40:43], v[136:139]
    v_mfma_f32_16x16x32_bf16 v[140:143], v[56:59], v[44:47], v[140:143]
    s_waitcnt lgkmcnt(5)
    v_mfma_f32_16x16x32_bf16 v[144:147], v[60:63], v[32:35], v[144:147]
    v_mfma_f32_16x16x32_bf16 v[148:151], v[60:63], v[36:39], v[148:151]
    v_mfma_f32_16x16x32_bf16 v[152:155], v[60:63], v[40:43], v[152:155]
    v_mfma_f32_16x16x32_bf16 v[156:159], v[60:63], v[44:47], v[156:159]
    s_waitcnt lgkmcnt(4)
    v_mfma_f32_16x16x32_bf16 v[160:163], v[32:35], v[64:67], v[160:163]
    v_mfma_f32_16x16x32_bf16 v[164:167], v[36:39], v[64:67], v[164:167]
    v_mfma_f32_16x16x32_bf16 v[168:171], v[40:43], v[64:67], v[168:171]
    v_mfma_f32_16x16x32_bf16 v[172:175], v[44:47], v[64:67], v[172:175]
    s_waitcnt lgkmcnt(3)
    v_mfma_f32_16x16x32_bf16 v[176:179], v[32:35], v[68:71], v[176:179]
    v_mfma_f32_16x16x32_bf16 v[180:183], v[36:39], v[68:71], v[180:183]
    v_mfma_f32_16x16x32_bf16 v[184:187], v[40:43], v[68:71], v[184:187]
    v_mfma_f32_16x16x32_bf16 v[188:191], v[44:47], v[68:71], v[188:191]
    s_waitcnt lgkmcnt(2)
    v_mfma_f32_16x16x32_bf16 v[192:195], v[32:35], v[72:75], v[192:195]
    v_mfma_f32_16x16x32_bf16 v[196:199], v[36:39], v[72:75], v[196:199]
    v_mfma_f32_16x16x32_bf16 v[200:203], v[40:43], v[72:75], v[200:203]
    v_mfma_f32_16x16x32_bf16 v[204:207], v[44:47], v[72:75], v[204:207]
    s_waitcnt lgkmcnt(1)
    v_mfma_f32_16x16x32_bf16 v[208:211], v[32:35], v[76:79], v[208:211]
    v_mfma_f32_16x16x32_bf16 v[212:215], v[36:39], v[76:79], v[212:215]
    v_mfma_f32_16x16x32_bf16 v[216:219], v[40:43], v[76:79], v[216:219]
    v_mfma_f32_16x16x32_bf16 v[220:223], v[44:47], v[76:79], v[220:223]
    s_waitcnt lgkmcnt(0)
    v_mfma_f32_16x16x32_bf16 v[224:227], v[32:35], v[80:83], v[224:227]
    v_mfma_f32_16x16x32_bf16 v[228:231], v[36:39], v[80:83], v[228:231]
    v_mfma_f32_16x16x32_bf16 v[232:235], v[40:43], v[80:83], v[232:235]
    v_mfma_f32_16x16x32_bf16 v[236:239], v[44:47], v[80:83], v[236:239]
    s_nop 7
    s_barrier
    s_and_b32 s7, s3, 1
    s_lshl_b32 s7, s7, 6
    v_and_b32 v240, 15, v2
    v_add_u32 v241, s7, v240
    v_lshrrev_b32 v242, 4, v2
    v_and_b32 v248, 1, v242
    v_lshlrev_b32 v248, 3, v248
    v_lshrrev_b32 v242, 1, v242
    s_movk_i32 s6, 128
    v_mul_lo_u32 v244, v241, s6
    v_add_u32 v244, v244, v248
    v_and_b32 v245, 7, v241
    v_xor_b32 v245, v245, v242
    s_lshr_b32 s6, s3, 1
    s_mul_i32 s6, s6, 20480
    s_add_u32 s6, s6, 0x8000
    v_lshlrev_b32 v246, 8, v240
    v_add3_u32 v246, v246, v248, s6
    v_xor_b32 v247, v240, v242
    s_lshr_b32 s7, s7, 3
    v_xor_b32 v247, s7, v247
    s_mov_b32 s6, 0xbfb8aa3b
    s_lshr_b32 s101, s3, 1
    s_mul_i32 s101, s101, 4
    s_waitcnt lgkmcnt(0)
    v_mul_f32 v16, s6, v96
    v_mul_f32 v17, s6, v97
    v_mul_f32 v18, s6, v98
    v_mul_f32 v19, s6, v99
    v_mul_f32 v20, s6, v100
    v_mul_f32 v21, s6, v101
    v_mul_f32 v22, s6, v102
    v_mul_f32 v23, s6, v103
    v_mul_f32 v24, s6, v104
    v_mul_f32 v25, s6, v105
    v_mul_f32 v26, s6, v106
    v_mul_f32 v27, s6, v107
    v_mul_f32 v28, s6, v108
    v_mul_f32 v29, s6, v109
    v_mul_f32 v30, s6, v110
    v_mul_f32 v31, s6, v111
    v_exp_f32 v16, v16
    v_exp_f32 v17, v17
    v_exp_f32 v18, v18
    v_exp_f32 v19, v19
    v_exp_f32 v20, v20
    v_exp_f32 v21, v21
    v_exp_f32 v22, v22
    v_exp_f32 v23, v23
    v_exp_f32 v24, v24
    v_exp_f32 v25, v25
    v_exp_f32 v26, v26
    v_exp_f32 v27, v27
    v_exp_f32 v28, v28
    v_exp_f32 v29, v29
    v_exp_f32 v30, v30
    v_exp_f32 v31, v31
    v_add_f32 v16, 1.0, v16
    v_add_f32 v17, 1.0, v17
    v_add_f32 v18, 1.0, v18
    v_add_f32 v19, 1.0, v19
    v_add_f32 v20, 1.0, v20
    v_add_f32 v21, 1.0, v21
    v_add_f32 v22, 1.0, v22
    v_add_f32 v23, 1.0, v23
    v_add_f32 v24, 1.0, v24
    v_add_f32 v25, 1.0, v25
    v_add_f32 v26, 1.0, v26
    v_add_f32 v27, 1.0, v27
    v_add_f32 v28, 1.0, v28
    v_add_f32 v29, 1.0, v29
    v_add_f32 v30, 1.0, v30
    v_add_f32 v31, 1.0, v31
    v_rcp_f32 v16, v16
    v_rcp_f32 v17, v17
    v_rcp_f32 v18, v18
    v_rcp_f32 v19, v19
    v_rcp_f32 v20, v20
    v_rcp_f32 v21, v21
    v_rcp_f32 v22, v22
    v_rcp_f32 v23, v23
    v_rcp_f32 v24, v24
    v_rcp_f32 v25, v25
    v_rcp_f32 v26, v26
    v_rcp_f32 v27, v27
    v_rcp_f32 v28, v28
    v_rcp_f32 v29, v29
    v_rcp_f32 v30, v30
    v_rcp_f32 v31, v31
    v_mul_f32 v96, v128, v16
    v_mul_f32 v97, v129, v17
    v_mul_f32 v98, v130, v18
    v_mul_f32 v99, v131, v19
    v_mul_f32 v100, v132, v20
    v_mul_f32 v101, v133, v21
    v_mul_f32 v102, v134, v22
    v_mul_f32 v103, v135, v23
    v_mul_f32 v104, v136, v24
    v_mul_f32 v105, v137, v25
    v_mul_f32 v106, v138, v26
    v_mul_f32 v107, v139, v27
    v_mul_f32 v108, v140, v28
    v_mul_f32 v109, v141, v29
    v_mul_f32 v110, v142, v30
    v_mul_f32 v111, v143, v31
    v_cvt_pk_bf16_f32 v32, v96, v97
    v_cvt_pk_bf16_f32 v33, v98, v99
    v_cvt_pk_bf16_f32 v34, v100, v101
    v_cvt_pk_bf16_f32 v35, v102, v103
    v_cvt_pk_bf16_f32 v36, v104, v105
    v_cvt_pk_bf16_f32 v37, v106, v107
    v_cvt_pk_bf16_f32 v38, v108, v109
    v_cvt_pk_bf16_f32 v39, v110, v111
    s_add_u32 s7, s101, 0
    v_xor_b32 v243, s7, v245
    v_lshl_add_u32 v243, v243, 4, v244
    ds_write_b64 v243, v[32:33] offset:0
    ds_write_b64 v243, v[34:35] offset:2048
    ds_write_b64 v243, v[36:37] offset:4096
    ds_write_b64 v243, v[38:39] offset:6144
    v_mul_f32 v16, s6, v112
    v_mul_f32 v17, s6, v113
    v_mul_f32 v18, s6, v114
    v_mul_f32 v19, s6, v115
    v_mul_f32 v20, s6, v116
    v_mul_f32 v21, s6, v117
    v_mul_f32 v22, s6, v118
    v_mul_f32 v23, s6, v119
    v_mul_f32 v24, s6, v120
    v_mul_f32 v25, s6, v121
    v_mul_f32 v26, s6, v122
    v_mul_f32 v27, s6, v123
    v_mul_f32 v28, s6, v124
    v_mul_f32 v29, s6, v125
    v_mul_f32 v30, s6, v126
    v_mul_f32 v31, s6, v127
    v_exp_f32 v16, v16
    v_exp_f32 v17, v17
    v_exp_f32 v18, v18
    v_exp_f32 v19, v19
    v_exp_f32 v20, v20
    v_exp_f32 v21, v21
    v_exp_f32 v22, v22
    v_exp_f32 v23, v23
    v_exp_f32 v24, v24
    v_exp_f32 v25, v25
    v_exp_f32 v26, v26
    v_exp_f32 v27, v27
    v_exp_f32 v28, v28
    v_exp_f32 v29, v29
    v_exp_f32 v30, v30
    v_exp_f32 v31, v31
    v_add_f32 v16, 1.0, v16
    v_add_f32 v17, 1.0, v17
    v_add_f32 v18, 1.0, v18
    v_add_f32 v19, 1.0, v19
    v_add_f32 v20, 1.0, v20
    v_add_f32 v21, 1.0, v21
    v_add_f32 v22, 1.0, v22
    v_add_f32 v23, 1.0, v23
    v_add_f32 v24, 1.0, v24
    v_add_f32 v25, 1.0, v25
    v_add_f32 v26, 1.0, v26
    v_add_f32 v27, 1.0, v27
    v_add_f32 v28, 1.0, v28
    v_add_f32 v29, 1.0, v29
    v_add_f32 v30, 1.0, v30
    v_add_f32 v31, 1.0, v31
    v_rcp_f32 v16, v16
    v_rcp_f32 v17, v17
    v_rcp_f32 v18, v18
    v_rcp_f32 v19, v19
    v_rcp_f32 v20, v20
    v_rcp_f32 v21, v21
    v_rcp_f32 v22, v22
    v_rcp_f32 v23, v23
    v_rcp_f32 v24, v24
    v_rcp_f32 v25, v25
    v_rcp_f32 v26, v26
    v_rcp_f32 v27, v27
    v_rcp_f32 v28, v28
    v_rcp_f32 v29, v29
    v_rcp_f32 v30, v30
    v_rcp_f32 v31, v31
    v_mul_f32 v112, v144, v16
    v_mul_f32 v113, v145, v17
    v_mul_f32 v114, v146, v18
    v_mul_f32 v115, v147, v19
    v_mul_f32 v116, v148, v20
    v_mul_f32 v117, v149, v21
    v_mul_f32 v118, v150, v22
    v_mul_f32 v119, v151, v23
    v_mul_f32 v120, v152, v24
    v_mul_f32 v121, v153, v25
    v_mul_f32 v122, v154, v26
    v_mul_f32 v123, v155, v27
    v_mul_f32 v124, v156, v28
    v_mul_f32 v125, v157, v29
    v_mul_f32 v126, v158, v30
    v_mul_f32 v127, v159, v31
    v_cvt_pk_bf16_f32 v32, v112, v113
    v_cvt_pk_bf16_f32 v33, v114, v115
    v_cvt_pk_bf16_f32 v34, v116, v117
    v_cvt_pk_bf16_f32 v35, v118, v119
    v_cvt_pk_bf16_f32 v36, v120, v121
    v_cvt_pk_bf16_f32 v37, v122, v123
    v_cvt_pk_bf16_f32 v38, v124, v125
    v_cvt_pk_bf16_f32 v39, v126, v127
    s_add_u32 s7, s101, 2
    v_xor_b32 v243, s7, v245
    v_lshl_add_u32 v243, v243, 4, v244
    ds_write_b64 v243, v[32:33] offset:0
    ds_write_b64 v243, v[34:35] offset:2048
    ds_write_b64 v243, v[36:37] offset:4096
    ds_write_b64 v243, v[38:39] offset:6144
    s_lshr_b32 s7, s3, 1
    s_mul_i32 s7, s7, 5
    s_add_u32 s7, s7, 0
    s_lshr_b32 s7, s7, 1
    s_add_u32 s7, s7, s99
    s_cmp_lt_u32 s7, 16
    s_cselect_b32 s84, 0, 0x80008000
    v_cvt_pk_bf16_f32 v48, v160, v161
    v_cvt_pk_bf16_f32 v49, v162, v163
    v_cvt_pk_bf16_f32 v50, v164, v165
    v_cvt_pk_bf16_f32 v51, v166, v167
    v_cvt_pk_bf16_f32 v52, v168, v169
    v_cvt_pk_bf16_f32 v53, v170, v171
    v_cvt_pk_bf16_f32 v54, v172, v173
    v_cvt_pk_bf16_f32 v55, v174, v175
    v_xor_b32 v48, s84, v48
    v_xor_b32 v49, s84, v49
    v_xor_b32 v50, s84, v50
    v_xor_b32 v51, s84, v51
    v_xor_b32 v52, s84, v52
    v_xor_b32 v53, s84, v53
    v_xor_b32 v54, s84, v54
    v_xor_b32 v55, s84, v55
    v_xor_b32 v243, 0, v247
    v_lshl_add_u32 v243, v243, 4, v246
    ds_write_b64 v243, v[48:49] offset:0
    v_xor_b32 v243, 2, v247
    v_lshl_add_u32 v243, v243, 4, v246
    ds_write_b64 v243, v[50:51] offset:0
    v_xor_b32 v243, 4, v247
    v_lshl_add_u32 v243, v243, 4, v246
    ds_write_b64 v243, v[52:53] offset:0
    v_xor_b32 v243, 6, v247
    v_lshl_add_u32 v243, v243, 4, v246
    ds_write_b64 v243, v[54:55] offset:0
    s_lshr_b32 s7, s3, 1
    s_mul_i32 s7, s7, 5
    s_add_u32 s7, s7, 1
    s_lshr_b32 s7, s7, 1
    s_add_u32 s7, s7, s99
    s_cmp_lt_u32 s7, 16
    s_cselect_b32 s84, 0, 0x80008000
    v_cvt_pk_bf16_f32 v48, v176, v177
    v_cvt_pk_bf16_f32 v49, v178, v179
    v_cvt_pk_bf16_f32 v50, v180, v181
    v_cvt_pk_bf16_f32 v51, v182, v183
    v_cvt_pk_bf16_f32 v52, v184, v185
    v_cvt_pk_bf16_f32 v53, v186, v187
    v_cvt_pk_bf16_f32 v54, v188, v189
    v_cvt_pk_bf16_f32 v55, v190, v191
    v_xor_b32 v48, s84, v48
    v_xor_b32 v49, s84, v49
    v_xor_b32 v50, s84, v50
    v_xor_b32 v51, s84, v51
    v_xor_b32 v52, s84, v52
    v_xor_b32 v53, s84, v53
    v_xor_b32 v54, s84, v54
    v_xor_b32 v55, s84, v55
    v_xor_b32 v243, 0, v247
    v_lshl_add_u32 v243, v243, 4, v246
    ds_write_b64 v243, v[48:49] offset:4096
    v_xor_b32 v243, 2, v247
    v_lshl_add_u32 v243, v243, 4, v246
    ds_write_b64 v243, v[50:51] offset:4096
    v_xor_b32 v243, 4, v247
    v_lshl_add_u32 v243, v243, 4, v246
    ds_write_b64 v243, v[52:53] offset:4096
    v_xor_b32 v243, 6, v247
    v_lshl_add_u32 v243, v243, 4, v246
    ds_write_b64 v243, v[54:55] offset:4096
    s_lshr_b32 s7, s3, 1
    s_mul_i32 s7, s7, 5
    s_add_u32 s7, s7, 2
    s_lshr_b32 s7, s7, 1
    s_add_u32 s7, s7, s99
    s_cmp_lt_u32 s7, 16
    s_cselect_b32 s84, 0, 0x80008000
    v_cvt_pk_bf16_f32 v48, v192, v193
    v_cvt_pk_bf16_f32 v49, v194, v195
    v_cvt_pk_bf16_f32 v50, v196, v197
    v_cvt_pk_bf16_f32 v51, v198, v199
    v_cvt_pk_bf16_f32 v52, v200, v201
    v_cvt_pk_bf16_f32 v53, v202, v203
    v_cvt_pk_bf16_f32 v54, v204, v205
    v_cvt_pk_bf16_f32 v55, v206, v207
    v_xor_b32 v48, s84, v48
    v_xor_b32 v49, s84, v49
    v_xor_b32 v50, s84, v50
    v_xor_b32 v51, s84, v51
    v_xor_b32 v52, s84, v52
    v_xor_b32 v53, s84, v53
    v_xor_b32 v54, s84, v54
    v_xor_b32 v55, s84, v55
    v_xor_b32 v243, 0, v247
    v_lshl_add_u32 v243, v243, 4, v246
    ds_write_b64 v243, v[48:49] offset:8192
    v_xor_b32 v243, 2, v247
    v_lshl_add_u32 v243, v243, 4, v246
    ds_write_b64 v243, v[50:51] offset:8192
    v_xor_b32 v243, 4, v247
    v_lshl_add_u32 v243, v243, 4, v246
    ds_write_b64 v243, v[52:53] offset:8192
    v_xor_b32 v243, 6, v247
    v_lshl_add_u32 v243, v243, 4, v246
    ds_write_b64 v243, v[54:55] offset:8192
    s_lshr_b32 s7, s3, 1
    s_mul_i32 s7, s7, 5
    s_add_u32 s7, s7, 3
    s_lshr_b32 s7, s7, 1
    s_add_u32 s7, s7, s99
    s_cmp_lt_u32 s7, 16
    s_cselect_b32 s84, 0, 0x80008000
    v_cvt_pk_bf16_f32 v48, v208, v209
    v_cvt_pk_bf16_f32 v49, v210, v211
    v_cvt_pk_bf16_f32 v50, v212, v213
    v_cvt_pk_bf16_f32 v51, v214, v215
    v_cvt_pk_bf16_f32 v52, v216, v217
    v_cvt_pk_bf16_f32 v53, v218, v219
    v_cvt_pk_bf16_f32 v54, v220, v221
    v_cvt_pk_bf16_f32 v55, v222, v223
    v_xor_b32 v48, s84, v48
    v_xor_b32 v49, s84, v49
    v_xor_b32 v50, s84, v50
    v_xor_b32 v51, s84, v51
    v_xor_b32 v52, s84, v52
    v_xor_b32 v53, s84, v53
    v_xor_b32 v54, s84, v54
    v_xor_b32 v55, s84, v55
    v_xor_b32 v243, 0, v247
    v_lshl_add_u32 v243, v243, 4, v246
    ds_write_b64 v243, v[48:49] offset:12288
    v_xor_b32 v243, 2, v247
    v_lshl_add_u32 v243, v243, 4, v246
    ds_write_b64 v243, v[50:51] offset:12288
    v_xor_b32 v243, 4, v247
    v_lshl_add_u32 v243, v243, 4, v246
    ds_write_b64 v243, v[52:53] offset:12288
    v_xor_b32 v243, 6, v247
    v_lshl_add_u32 v243, v243, 4, v246
    ds_write_b64 v243, v[54:55] offset:12288
    s_lshr_b32 s7, s3, 1
    s_mul_i32 s7, s7, 5
    s_add_u32 s7, s7, 4
    s_lshr_b32 s7, s7, 1
    s_add_u32 s7, s7, s99
    s_cmp_lt_u32 s7, 16
    s_cselect_b32 s84, 0, 0x80008000
    v_cvt_pk_bf16_f32 v48, v224, v225
    v_cvt_pk_bf16_f32 v49, v226, v227
    v_cvt_pk_bf16_f32 v50, v228, v229
    v_cvt_pk_bf16_f32 v51, v230, v231
    v_cvt_pk_bf16_f32 v52, v232, v233
    v_cvt_pk_bf16_f32 v53, v234, v235
    v_cvt_pk_bf16_f32 v54, v236, v237
    v_cvt_pk_bf16_f32 v55, v238, v239
    v_xor_b32 v48, s84, v48
    v_xor_b32 v49, s84, v49
    v_xor_b32 v50, s84, v50
    v_xor_b32 v51, s84, v51
    v_xor_b32 v52, s84, v52
    v_xor_b32 v53, s84, v53
    v_xor_b32 v54, s84, v54
    v_xor_b32 v55, s84, v55
    v_xor_b32 v243, 0, v247
    v_lshl_add_u32 v243, v243, 4, v246
    ds_write_b64 v243, v[48:49] offset:16384
    v_xor_b32 v243, 2, v247
    v_lshl_add_u32 v243, v243, 4, v246
    ds_write_b64 v243, v[50:51] offset:16384
    v_xor_b32 v243, 4, v247
    v_lshl_add_u32 v243, v243, 4, v246
    ds_write_b64 v243, v[52:53] offset:16384
    v_xor_b32 v243, 6, v247
    v_lshl_add_u32 v243, v243, 4, v246
    ds_write_b64 v243, v[54:55] offset:16384
    s_waitcnt lgkmcnt(0)
    s_branch K1_STC
K1_STB:
    s_barrier
    v_lshrrev_b32 v4, 4, v2
    s_lshl_b32 s6, s87, 4
    v_add_u32 v4, s6, v4
    v_and_b32 v5, 15, v2
    v_add_u32 v6, 0, v4
    s_movk_i32 s7, 256
    v_mul_lo_u32 v7, v6, s7
    v_lshl_add_u32 v7, v5, 4, v7
    ds_read_b128 v[16:19], v7
    v_and_b32 v7, 15, v6
    v_xor_b32 v7, v7, v5
    v_lshlrev_b32 v7, 4, v7
    v_lshl_add_u32 v8, v6, 12, v7
    v_add_u32 v6, 4, v4
    s_movk_i32 s7, 256
    v_mul_lo_u32 v7, v6, s7
    v_lshl_add_u32 v7, v5, 4, v7
    ds_read_b128 v[20:23], v7
    v_and_b32 v7, 15, v6
    v_xor_b32 v7, v7, v5
    v_lshlrev_b32 v7, 4, v7
    v_lshl_add_u32 v9, v6, 12, v7
    v_add_u32 v6, 8, v4
    s_movk_i32 s7, 256
    v_mul_lo_u32 v7, v6, s7
    v_lshl_add_u32 v7, v5, 4, v7
    ds_read_b128 v[24:27], v7
    v_and_b32 v7, 15, v6
    v_xor_b32 v7, v7, v5
    v_lshlrev_b32 v7, 4, v7
    v_lshl_add_u32 v10, v6, 12, v7
    v_add_u32 v6, 12, v4
    s_movk_i32 s7, 256
    v_mul_lo_u32 v7, v6, s7
    v_lshl_add_u32 v7, v5, 4, v7
    ds_read_b128 v[28:31], v7
    v_and_b32 v7, 15, v6
    v_xor_b32 v7, v7, v5
    v_lshlrev_b32 v7, 4, v7
    v_lshl_add_u32 v11, v6, 12, v7
    s_lshl_b32 s6, s96, 19
    s_lshl_b32 s7, s98, 1
    s_add_u32 s101, s6, s7
    v_lshrrev_b32 v4, 4, v2
    s_lshl_b32 s6, s87, 2
    v_add_u32 v4, s6, v4
    v_and_b32 v5, 15, v2
    v_lshlrev_b32 v6, 8, v4
    v_lshl_add_u32 v6, v5, 4, v6
    v_add_u32 v6, 0x8000, v6
    ds_read_b128 v[32:35], v6 offset:0
    v_and_b32 v6, 15, v4
    v_xor_b32 v6, v6, v5
    v_lshlrev_b32 v6, 4, v6
    s_mov_b32 s7, 11776
    v_mul_lo_u32 v7, v4, s7
    v_add_u32 v12, v6, v7
    s_waitcnt lgkmcnt(0)
    buffer_store_dwordx4 v[16:19], v8, s[20:23], s101 offen sc0 sc1
    buffer_store_dwordx4 v[20:23], v9, s[20:23], s101 offen sc0 sc1
    buffer_store_dwordx4 v[24:27], v10, s[20:23], s101 offen sc0 sc1
    buffer_store_dwordx4 v[28:31], v11, s[20:23], s101 offen sc0 sc1
    s_add_u32 s7, s99, 0
    s_cmp_lt_u32 s7, 16
    s_cselect_b32 s86, 0, 4096
    s_and_b32 s7, s7, 15
    s_mul_i32 s7, s7, 376832
    s_add_u32 s7, s7, s86
    s_lshl_b32 s86, s96, 8
    s_add_u32 s7, s7, s86
    buffer_store_dwordx4 v[32:35], v12, s[24:27], s7 offen sc0 sc1
    s_endpgm
K1_STC:
    s_barrier
    v_lshrrev_b32 v4, 3, v2
    s_lshl_b32 s6, s87, 4
    v_add_u32 v4, s6, v4
    v_and_b32 v5, 7, v2
    v_add_u32 v6, 0, v4
    s_movk_i32 s7, 128
    v_mul_lo_u32 v7, v6, s7
    v_lshl_add_u32 v7, v5, 4, v7
    ds_read_b128 v[16:19], v7
    v_and_b32 v7, 7, v6
    v_xor_b32 v7, v7, v5
    v_lshlrev_b32 v7, 4, v7
    v_lshl_add_u32 v8, v6, 12, v7
    v_add_u32 v6, 8, v4
    s_movk_i32 s7, 128
    v_mul_lo_u32 v7, v6, s7
    v_lshl_add_u32 v7, v5, 4, v7
    ds_read_b128 v[20:23], v7
    v_and_b32 v7, 7, v6
    v_xor_b32 v7, v7, v5
    v_lshlrev_b32 v7, 4, v7
    v_lshl_add_u32 v9, v6, 12, v7
    s_lshl_b32 s6, s96, 19
    s_lshl_b32 s7, s98, 1
    s_add_u32 s101, s6, s7
    v_lshrrev_b32 v4, 4, v2
    s_lshl_b32 s6, s87, 2
    v_add_u32 v4, s6, v4
    v_and_b32 v5, 15, v2
    v_lshlrev_b32 v6, 8, v4
    v_lshl_add_u32 v6, v5, 4, v6
    v_add_u32 v6, 0x8000, v6
    ds_read_b128 v[32:35], v6 offset:0
    ds_read_b128 v[36:39], v6 offset:8192
    ds_read_b128 v[40:43], v6 offset:16384
    ds_read_b128 v[44:47], v6 offset:24576
    ds_read_b128 v[48:51], v6 offset:32768
    v_and_b32 v6, 15, v4
    v_xor_b32 v6, v6, v5
    v_lshlrev_b32 v6, 4, v6
    s_mov_b32 s7, 11776
    v_mul_lo_u32 v7, v4, s7
    v_add_u32 v12, v6, v7
    s_waitcnt lgkmcnt(0)
    buffer_store_dwordx4 v[16:19], v8, s[20:23], s101 offen sc0 sc1
    buffer_store_dwordx4 v[20:23], v9, s[20:23], s101 offen sc0 sc1
    s_add_u32 s7, s99, 0
    s_cmp_lt_u32 s7, 16
    s_cselect_b32 s86, 0, 4096
    s_and_b32 s7, s7, 15
    s_mul_i32 s7, s7, 376832
    s_add_u32 s7, s7, s86
    s_lshl_b32 s86, s96, 8
    s_add_u32 s7, s7, s86
    buffer_store_dwordx4 v[32:35], v12, s[24:27], s7 offen sc0 sc1
    s_add_u32 s7, s99, 1
    s_cmp_lt_u32 s7, 16
    s_cselect_b32 s86, 0, 4096
    s_and_b32 s7, s7, 15
    s_mul_i32 s7, s7, 376832
    s_add_u32 s7, s7, s86
    s_lshl_b32 s86, s96, 8
    s_add_u32 s7, s7, s86
    buffer_store_dwordx4 v[36:39], v12, s[24:27], s7 offen sc0 sc1
    s_add_u32 s7, s99, 2
    s_cmp_lt_u32 s7, 16
    s_cselect_b32 s86, 0, 4096
    s_and_b32 s7, s7, 15
    s_mul_i32 s7, s7, 376832
    s_add_u32 s7, s7, s86
    s_lshl_b32 s86, s96, 8
    s_add_u32 s7, s7, s86
    buffer_store_dwordx4 v[40:43], v12, s[24:27], s7 offen sc0 sc1
    s_add_u32 s7, s99, 3
    s_cmp_lt_u32 s7, 16
    s_cselect_b32 s86, 0, 4096
    s_and_b32 s7, s7, 15
    s_mul_i32 s7, s7, 376832
    s_add_u32 s7, s7, s86
    s_lshl_b32 s86, s96, 8
    s_add_u32 s7, s7, s86
    buffer_store_dwordx4 v[44:47], v12, s[24:27], s7 offen sc0 sc1
    s_add_u32 s7, s99, 4
    s_cmp_lt_u32 s7, 16
    s_cselect_b32 s86, 0, 4096
    s_and_b32 s7, s7, 15
    s_mul_i32 s7, s7, 376832
    s_add_u32 s7, s7, s86
    s_lshl_b32 s86, s96, 8
    s_add_u32 s7, s7, s86
    buffer_store_dwordx4 v[48:51], v12, s[24:27], s7 offen sc0 sc1
    s_endpgm
K1_END:
    s_endpgm
.globl k2_kernel
.p2align 8
.type k2_kernel,@function
k2_kernel:
    s_cmp_ge_u32 s2, 256
    s_cbranch_scc1 K2_END
    s_load_dwordx4 s[44:47], s[0:1], 8
    s_load_dwordx2 s[50:51], s[0:1], 96
    v_lshrrev_b32 v1, 6, v0
    v_and_b32 v2, 63, v0
    s_and_b32 s30, s2, 7
    v_readfirstlane_b32 s41, v1
    s_lshr_b32 s26, s2, 3
    s_and_b32 s25, s30, 3
    s_and_b32 s32, s26, 3
    s_lshr_b32 s28, s30, 2
    s_lshl_b32 s28, s28, 3
    s_lshr_b32 s29, s26, 2
    s_add_u32 s33, s28, s29
    s_and_b32 s24, s41, 3
    s_cmp_eq_u32 s25, 0
    s_cselect_b32 s43, 0, s43
    s_cselect_b32 s31, 23, s31
    s_cmp_eq_u32 s25, 1
    s_cselect_b32 s43, 23, s43
    s_cselect_b32 s31, 23, s31
    s_cmp_eq_u32 s25, 2
    s_cselect_b32 s43, 46, s43
    s_cselect_b32 s31, 23, s31
    s_cmp_eq_u32 s25, 3
    s_cselect_b32 s43, 69, s43
    s_cselect_b32 s31, 23, s31
    s_sub_i32 s36, 64, s43
    s_max_i32 s36, s36, 0
    s_min_i32 s36, s36, s31
    s_cmp_ge_u32 s41, 4
    s_cbranch_scc0 K2_COMP
    s_lshl_b32 s30, s32, 7
    v_lshrrev_b32 v4, 3, v2
    s_mul_i32 s28, s24, 32
    s_add_u32 s28, s28, s30
    v_add_u32 v4, s28, v4
    s_mov_b32 s29, 11776
    v_mul_lo_u32 v4, v4, s29
    v_lshrrev_b32 v5, 4, v2
    v_and_b32 v6, 7, v2
    v_add_u32 v7, 0, v5
    v_xor_b32 v7, v7, v6
    v_lshlrev_b32 v7, 4, v7
    v_add_u32 v7, v7, v4
    v_add_u32 v16, 0x0, v7
    v_add_u32 v18, 0x2d800, v7
    v_add_u32 v7, 4, v5
    v_xor_b32 v7, v7, v6
    v_lshlrev_b32 v7, 4, v7
    v_add_u32 v7, v7, v4
    v_add_u32 v17, 0x16c00, v7
    v_add_u32 v19, 0x44400, v7
    s_lshl_b32 s30, s33, 7
    v_lshrrev_b32 v4, 3, v2
    s_mul_i32 s28, s24, 32
    s_add_u32 s28, s28, s30
    v_add_u32 v4, s28, v4
    s_mov_b32 s29, 4096
    v_mul_lo_u32 v4, v4, s29
    v_lshrrev_b32 v5, 4, v2
    v_and_b32 v6, 7, v2
    v_add_u32 v7, 0, v5
    v_xor_b32 v7, v7, v6
    v_lshlrev_b32 v7, 4, v7
    v_add_u32 v7, v7, v4
    v_add_u32 v24, 0x0, v7
    v_add_u32 v26, 0xf800, v7
    v_add_u32 v7, 4, v5
    v_xor_b32 v7, v7, v6
    v_lshlrev_b32 v7, 4, v7
    v_add_u32 v7, v7, v4
    v_add_u32 v25, 0x7c00, v7
    v_add_u32 v27, 0x17400, v7
    s_lshl_b32 s27, s24, 12
    s_lshl_b32 s42, s24, 13
    s_mul_i32 s60, s32, 6
    s_and_b32 s28, s33, 7
    s_mul_i32 s28, s28, 3
    s_add_u32 s60, s60, s28
    s_sub_u32 s28, s60, s36
    s_cmp_ge_u32 s60, s36
    s_cselect_b32 s60, s28, s60
    s_sub_u32 s28, s60, s36
    s_cmp_ge_u32 s60, s36
    s_cselect_b32 s60, s28, s60
    s_sub_u32 s28, s60, s36
    s_cmp_ge_u32 s60, s36
    s_cselect_b32 s60, s28, s60
    s_cmp_eq_u32 s36, 0
    s_cselect_b32 s60, 0, s60
    s_mov_b32 s61, 0
    s_mov_b32 s37, 0
    s_mov_b32 s14, 0x800000
    s_mov_b32 s15, 0x00020000
    s_waitcnt lgkmcnt(0)
    s_mov_b32 s8, s50
    s_mov_b32 s9, s51
    s_and_b32 s9, s9, 0xffff
    s_mov_b32 s10, 0x5c0000
    s_mov_b32 s11, 0x00020000
    s_add_u32 s48, s50, 0x800000
    s_addc_u32 s49, s51, 0
    s_add_u32 m0, s37, s27
    s_add_u32 s28, s61, s60
    s_sub_u32 s29, s28, s36
    s_cmp_ge_u32 s28, s36
    s_cselect_b32 s28, s29, s28
    s_cmp_lt_u32 s61, s36
    s_cselect_b32 s28, s28, s61
    s_add_u32 s34, s43, s28
    s_add_u32 s61, s61, 1
    s_lshl_b32 s39, s34, 7
    buffer_load_dwordx4 v16, s[8:11], s39 offen offset:0 lds
    buffer_load_dwordx4 v17, s[8:11], s39 offen offset:1024 lds
    buffer_load_dwordx4 v18, s[8:11], s39 offen offset:2048 lds
    buffer_load_dwordx4 v19, s[8:11], s39 offen offset:3072 lds
    s_add_u32 s28, s37, s27
    s_add_u32 m0, s28, 16384
    s_cmp_lt_u32 s34, 32
    s_cselect_b32 s12, s44, s46
    s_cselect_b32 s13, s45, s47
    s_cmp_lt_u32 s34, 64
    s_cselect_b32 s12, s12, s48
    s_cselect_b32 s13, s13, s49
    s_and_b32 s13, s13, 0xffff
    s_and_b32 s40, s34, 31
    s_lshl_b32 s40, s40, 7
    buffer_load_dwordx4 v24, s[12:15], s40 offen offset:0 lds
    buffer_load_dwordx4 v25, s[12:15], s40 offen offset:1024 lds
    buffer_load_dwordx4 v26, s[12:15], s40 offen offset:2048 lds
    buffer_load_dwordx4 v27, s[12:15], s40 offen offset:3072 lds
    s_add_u32 s37, s37, 32768
    s_cmp_ge_u32 s37, 163840
    s_cselect_b32 s37, 0, s37
    s_add_u32 m0, s37, s27
    s_add_u32 s28, s61, s60
    s_sub_u32 s29, s28, s36
    s_cmp_ge_u32 s28, s36
    s_cselect_b32 s28, s29, s28
    s_cmp_lt_u32 s61, s36
    s_cselect_b32 s28, s28, s61
    s_add_u32 s34, s43, s28
    s_add_u32 s61, s61, 1
    s_lshl_b32 s39, s34, 7
    buffer_load_dwordx4 v16, s[8:11], s39 offen offset:0 lds
    buffer_load_dwordx4 v17, s[8:11], s39 offen offset:1024 lds
    buffer_load_dwordx4 v18, s[8:11], s39 offen offset:2048 lds
    buffer_load_dwordx4 v19, s[8:11], s39 offen offset:3072 lds
    s_add_u32 s28, s37, s27
    s_add_u32 m0, s28, 16384
    s_cmp_lt_u32 s34, 32
    s_cselect_b32 s12, s44, s46
    s_cselect_b32 s13, s45, s47
    s_cmp_lt_u32 s34, 64
    s_cselect_b32 s12, s12, s48
    s_cselect_b32 s13, s13, s49
    s_and_b32 s13, s13, 0xffff
    s_and_b32 s40, s34, 31
    s_lshl_b32 s40, s40, 7
    buffer_load_dwordx4 v24, s[12:15], s40 offen offset:0 lds
    buffer_load_dwordx4 v25, s[12:15], s40 offen offset:1024 lds
    buffer_load_dwordx4 v26, s[12:15], s40 offen offset:2048 lds
    buffer_load_dwordx4 v27, s[12:15], s40 offen offset:3072 lds
    s_add_u32 s37, s37, 32768
    s_cmp_ge_u32 s37, 163840
    s_cselect_b32 s37, 0, s37
    s_waitcnt vmcnt(8)
    s_barrier
    s_add_u32 m0, s37, s27
    s_add_u32 s28, s61, s60
    s_sub_u32 s29, s28, s36
    s_cmp_ge_u32 s28, s36
    s_cselect_b32 s28, s29, s28
    s_cmp_lt_u32 s61, s36
    s_cselect_b32 s28, s28, s61
    s_add_u32 s34, s43, s28
    s_add_u32 s61, s61, 1
    s_lshl_b32 s39, s34, 7
    buffer_load_dwordx4 v16, s[8:11], s39 offen offset:0 lds
    buffer_load_dwordx4 v17, s[8:11], s39 offen offset:1024 lds
    buffer_load_dwordx4 v18, s[8:11], s39 offen offset:2048 lds
    buffer_load_dwordx4 v19, s[8:11], s39 offen offset:3072 lds
    s_add_u32 s28, s37, s27
    s_add_u32 m0, s28, 16384
    s_cmp_lt_u32 s34, 32
    s_cselect_b32 s12, s44, s46
    s_cselect_b32 s13, s45, s47
    s_cmp_lt_u32 s34, 64
    s_cselect_b32 s12, s12, s48
    s_cselect_b32 s13, s13, s49
    s_and_b32 s13, s13, 0xffff
    s_and_b32 s40, s34, 31
    s_lshl_b32 s40, s40, 7
    buffer_load_dwordx4 v24, s[12:15], s40 offen offset:0 lds
    buffer_load_dwordx4 v25, s[12:15], s40 offen offset:1024 lds
    buffer_load_dwordx4 v26, s[12:15], s40 offen offset:2048 lds
    buffer_load_dwordx4 v27, s[12:15], s40 offen offset:3072 lds
    s_add_u32 s37, s37, 32768
    s_cmp_ge_u32 s37, 163840
    s_cselect_b32 s37, 0, s37
    s_add_u32 m0, s37, s27
    s_add_u32 s28, s61, s60
    s_sub_u32 s29, s28, s36
    s_cmp_ge_u32 s28, s36
    s_cselect_b32 s28, s29, s28
    s_cmp_lt_u32 s61, s36
    s_cselect_b32 s28, s28, s61
    s_add_u32 s34, s43, s28
    s_add_u32 s61, s61, 1
    s_lshl_b32 s39, s34, 7
    buffer_load_dwordx4 v16, s[8:11], s39 offen offset:0 lds
    buffer_load_dwordx4 v17, s[8:11], s39 offen offset:1024 lds
    buffer_load_dwordx4 v18, s[8:11], s39 offen offset:2048 lds
    buffer_load_dwordx4 v19, s[8:11], s39 offen offset:3072 lds
    s_add_u32 s28, s37, s27
    s_add_u32 m0, s28, 16384
    s_cmp_lt_u32 s34, 32
    s_cselect_b32 s12, s44, s46
    s_cselect_b32 s13, s45, s47
    s_cmp_lt_u32 s34, 64
    s_cselect_b32 s12, s12, s48
    s_cselect_b32 s13, s13, s49
    s_and_b32 s13, s13, 0xffff
    s_and_b32 s40, s34, 31
    s_lshl_b32 s40, s40, 7
    buffer_load_dwordx4 v24, s[12:15], s40 offen offset:0 lds
    buffer_load_dwordx4 v25, s[12:15], s40 offen offset:1024 lds
    buffer_load_dwordx4 v26, s[12:15], s40 offen offset:2048 lds
    buffer_load_dwordx4 v27, s[12:15], s40 offen offset:3072 lds
    s_add_u32 s37, s37, 32768
    s_cmp_ge_u32 s37, 163840
    s_cselect_b32 s37, 0, s37
    s_sub_u32 s35, s31, 4
K2_LLOOP:
    s_add_u32 m0, s37, s27
    s_add_u32 s28, s61, s60
    s_sub_u32 s29, s28, s36
    s_cmp_ge_u32 s28, s36
    s_cselect_b32 s28, s29, s28
    s_cmp_lt_u32 s61, s36
    s_cselect_b32 s28, s28, s61
    s_add_u32 s34, s43, s28
    s_add_u32 s61, s61, 1
    s_lshl_b32 s39, s34, 7
    buffer_load_dwordx4 v16, s[8:11], s39 offen offset:0 lds
    buffer_load_dwordx4 v17, s[8:11], s39 offen offset:1024 lds
    buffer_load_dwordx4 v18, s[8:11], s39 offen offset:2048 lds
    buffer_load_dwordx4 v19, s[8:11], s39 offen offset:3072 lds
    s_add_u32 s28, s37, s27
    s_add_u32 m0, s28, 16384
    s_cmp_lt_u32 s34, 32
    s_cselect_b32 s12, s44, s46
    s_cselect_b32 s13, s45, s47
    s_cmp_lt_u32 s34, 64
    s_cselect_b32 s12, s12, s48
    s_cselect_b32 s13, s13, s49
    s_and_b32 s13, s13, 0xffff
    s_and_b32 s40, s34, 31
    s_lshl_b32 s40, s40, 7
    buffer_load_dwordx4 v24, s[12:15], s40 offen offset:0 lds
    buffer_load_dwordx4 v25, s[12:15], s40 offen offset:1024 lds
    buffer_load_dwordx4 v26, s[12:15], s40 offen offset:2048 lds
    buffer_load_dwordx4 v27, s[12:15], s40 offen offset:3072 lds
    s_add_u32 s37, s37, 32768
    s_cmp_ge_u32 s37, 163840
    s_cselect_b32 s37, 0, s37
    s_waitcnt vmcnt(24)
    s_barrier
    s_sub_u32 s35, s35, 1
    s_cmp_lg_u32 s35, 0
    s_cbranch_scc1 K2_LLOOP
    s_waitcnt vmcnt(16)
    s_barrier
    s_waitcnt vmcnt(8)
    s_barrier
    s_waitcnt vmcnt(0)
    s_barrier
    s_endpgm
K2_COMP:
    v_and_b32 v4, 15, v2
    v_lshrrev_b32 v5, 1, v4
    v_lshrrev_b32 v6, 4, v2
    v_xor_b32 v5, v5, v6
    v_lshlrev_b32 v5, 4, v5
    v_lshlrev_b32 v6, 7, v4
    s_lshr_b32 s28, s24, 1
    s_lshl_b32 s28, s28, 13
    s_and_b32 s29, s24, 1
    s_lshl_b32 s29, s29, 13
    s_add_u32 s29, s29, 16384
    v_xor_b32 v7, 0, v5
    v_add3_u32 v240, v7, v6, s28
    v_add3_u32 v242, v7, v6, s29
    v_xor_b32 v7, 64, v5
    v_add3_u32 v241, v7, v6, s28
    v_add3_u32 v243, v7, v6, s29
    s_waitcnt lgkmcnt(0)
    s_add_u32 s16, s50, 0x1000000
    s_addc_u32 s17, s51, 0
    s_and_b32 s17, s17, 0xffff
    s_mov_b32 s18, 0x2000
    s_mov_b32 s19, 0x00020000
    s_add_u32 s20, s50, 0x2000000
    s_addc_u32 s21, s51, 0
    s_and_b32 s21, s21, 0xffff
    s_mov_b32 s22, 0x1000000
    s_mov_b32 s23, 0x00020000
    s_add_u32 s52, s50, 0x1100000
    s_addc_u32 s53, s51, 0
    s_and_b32 s53, s53, 0xffff
    s_mov_b32 s54, 0x10000
    s_mov_b32 s55, 0x00020000
    s_load_dwordx2 s[62:63], s[0:1], 80
    s_lshl_b32 s28, s33, 7
    s_and_b32 s29, s24, 1
    s_lshl_b32 s29, s29, 6
    s_add_u32 s30, s28, s29
    s_mov_b32 s64, s30
    v_add_u32 v4, s30, v4
    v_lshlrev_b32 v4, 2, v4
    buffer_load_dword v248, v4, s[16:19], 0 offen offset:0
    buffer_load_dword v249, v4, s[16:19], 0 offen offset:64
    buffer_load_dword v250, v4, s[16:19], 0 offen offset:128
    buffer_load_dword v251, v4, s[16:19], 0 offen offset:192
    v_mov_b32 v112, 0
    v_mov_b32 v176, 0
    v_mov_b32 v113, 0
    v_mov_b32 v177, 0
    v_mov_b32 v114, 0
    v_mov_b32 v178, 0
    v_mov_b32 v115, 0
    v_mov_b32 v179, 0
    v_mov_b32 v116, 0
    v_mov_b32 v180, 0
    v_mov_b32 v117, 0
    v_mov_b32 v181, 0
    v_mov_b32 v118, 0
    v_mov_b32 v182, 0
    v_mov_b32 v119, 0
    v_mov_b32 v183, 0
    v_mov_b32 v120, 0
    v_mov_b32 v184, 0
    v_mov_b32 v121, 0
    v_mov_b32 v185, 0
    v_mov_b32 v122, 0
    v_mov_b32 v186, 0
    v_mov_b32 v123, 0
    v_mov_b32 v187, 0
    v_mov_b32 v124, 0
    v_mov_b32 v188, 0
    v_mov_b32 v125, 0
    v_mov_b32 v189, 0
    v_mov_b32 v126, 0
    v_mov_b32 v190, 0
    v_mov_b32 v127, 0
    v_mov_b32 v191, 0
    v_mov_b32 v128, 0
    v_mov_b32 v192, 0
    v_mov_b32 v129, 0
    v_mov_b32 v193, 0
    v_mov_b32 v130, 0
    v_mov_b32 v194, 0
    v_mov_b32 v131, 0
    v_mov_b32 v195, 0
    v_mov_b32 v132, 0
    v_mov_b32 v196, 0
    v_mov_b32 v133, 0
    v_mov_b32 v197, 0
    v_mov_b32 v134, 0
    v_mov_b32 v198, 0
    v_mov_b32 v135, 0
    v_mov_b32 v199, 0
    v_mov_b32 v136, 0
    v_mov_b32 v200, 0
    v_mov_b32 v137, 0
    v_mov_b32 v201, 0
    v_mov_b32 v138, 0
    v_mov_b32 v202, 0
    v_mov_b32 v139, 0
    v_mov_b32 v203, 0
    v_mov_b32 v140, 0
    v_mov_b32 v204, 0
    v_mov_b32 v141, 0
    v_mov_b32 v205, 0
    v_mov_b32 v142, 0
    v_mov_b32 v206, 0
    v_mov_b32 v143, 0
    v_mov_b32 v207, 0
    v_mov_b32 v144, 0
    v_mov_b32 v208, 0
    v_mov_b32 v145, 0
    v_mov_b32 v209, 0
    v_mov_b32 v146, 0
    v_mov_b32 v210, 0
    v_mov_b32 v147, 0
    v_mov_b32 v211, 0
    v_mov_b32 v148, 0
    v_mov_b32 v212, 0
    v_mov_b32 v149, 0
    v_mov_b32 v213, 0
    v_mov_b32 v150, 0
    v_mov_b32 v214, 0
    v_mov_b32 v151, 0
    v_mov_b32 v215, 0
    v_mov_b32 v152, 0
    v_mov_b32 v216, 0
    v_mov_b32 v153, 0
    v_mov_b32 v217, 0
    v_mov_b32 v154, 0
    v_mov_b32 v218, 0
    v_mov_b32 v155, 0
    v_mov_b32 v219, 0
    v_mov_b32 v156, 0
    v_mov_b32 v220, 0
    v_mov_b32 v157, 0
    v_mov_b32 v221, 0
    v_mov_b32 v158, 0
    v_mov_b32 v222, 0
    v_mov_b32 v159, 0
    v_mov_b32 v223, 0
    v_mov_b32 v160, 0
    v_mov_b32 v224, 0
    v_mov_b32 v161, 0
    v_mov_b32 v225, 0
    v_mov_b32 v162, 0
    v_mov_b32 v226, 0
    v_mov_b32 v163, 0
    v_mov_b32 v227, 0
    v_mov_b32 v164, 0
    v_mov_b32 v228, 0
    v_mov_b32 v165, 0
    v_mov_b32 v229, 0
    v_mov_b32 v166, 0
    v_mov_b32 v230, 0
    v_mov_b32 v167, 0
    v_mov_b32 v231, 0
    v_mov_b32 v168, 0
    v_mov_b32 v232, 0
    v_mov_b32 v169, 0
    v_mov_b32 v233, 0
    v_mov_b32 v170, 0
    v_mov_b32 v234, 0
    v_mov_b32 v171, 0
    v_mov_b32 v235, 0
    v_mov_b32 v172, 0
    v_mov_b32 v236, 0
    v_mov_b32 v173, 0
    v_mov_b32 v237, 0
    v_mov_b32 v174, 0
    v_mov_b32 v238, 0
    v_mov_b32 v175, 0
    v_mov_b32 v239, 0
    s_mov_b32 s38, 0
    s_mov_b32 s35, 0
    s_waitcnt vmcnt(0) lgkmcnt(0)
    s_barrier
    v_add_u32 v244, s38, v240
    v_add_u32 v246, s38, v242
    v_add_u32 v245, s38, v241
    v_add_u32 v247, s38, v243
    s_add_u32 s38, s38, 32768
    s_cmp_ge_u32 s38, 163840
    s_cselect_b32 s38, 0, s38
    ds_read_b128 v[16:19], v244
    ds_read_b128 v[48:51], v246 offset:0
    ds_read_b128 v[52:55], v246 offset:2048
    ds_read_b128 v[56:59], v246 offset:4096
    ds_read_b128 v[60:63], v246 offset:6144
    ds_read_b128 v[20:23], v244 offset:2048
    ds_read_b128 v[24:27], v244 offset:4096
    ds_read_b128 v[28:31], v244 offset:6144
    s_sub_u32 s30, s31, 1
    s_mov_b32 s65, s30
K2_LOOP:
    s_cmp_eq_u32 s35, s36
    s_cbranch_scc1 K2_BND
K2_BACK:
    s_waitcnt lgkmcnt(0)
    v_mfma_f32_16x16x32_bf16 v[112:115], v[16:19], v[48:51], v[112:115]
    ds_read_b128 v[64:67], v245
    v_mfma_f32_16x16x32_bf16 v[116:119], v[16:19], v[52:55], v[116:119]
    ds_read_b128 v[96:99], v247 offset:0
    v_mfma_f32_16x16x32_bf16 v[120:123], v[16:19], v[56:59], v[120:123]
    ds_read_b128 v[100:103], v247 offset:2048
    v_mfma_f32_16x16x32_bf16 v[124:127], v[16:19], v[60:63], v[124:127]
    ds_read_b128 v[104:107], v247 offset:4096
    v_mfma_f32_16x16x32_bf16 v[128:131], v[20:23], v[48:51], v[128:131]
    ds_read_b128 v[108:111], v247 offset:6144
    v_mfma_f32_16x16x32_bf16 v[132:135], v[20:23], v[52:55], v[132:135]
    ds_read_b128 v[68:71], v245 offset:2048
    v_mfma_f32_16x16x32_bf16 v[136:139], v[20:23], v[56:59], v[136:139]
    ds_read_b128 v[72:75], v245 offset:4096
    v_mfma_f32_16x16x32_bf16 v[140:143], v[20:23], v[60:63], v[140:143]
    ds_read_b128 v[76:79], v245 offset:6144
    v_mfma_f32_16x16x32_bf16 v[144:147], v[24:27], v[48:51], v[144:147]
    v_mfma_f32_16x16x32_bf16 v[148:151], v[24:27], v[52:55], v[148:151]
    v_mfma_f32_16x16x32_bf16 v[152:155], v[24:27], v[56:59], v[152:155]
    v_mfma_f32_16x16x32_bf16 v[156:159], v[24:27], v[60:63], v[156:159]
    v_mfma_f32_16x16x32_bf16 v[160:163], v[28:31], v[48:51], v[160:163]
    v_mfma_f32_16x16x32_bf16 v[164:167], v[28:31], v[52:55], v[164:167]
    v_mfma_f32_16x16x32_bf16 v[168:171], v[28:31], v[56:59], v[168:171]
    v_mfma_f32_16x16x32_bf16 v[172:175], v[28:31], v[60:63], v[172:175]
    s_waitcnt lgkmcnt(0)
    s_barrier
    v_mfma_f32_16x16x32_bf16 v[112:115], v[64:67], v[96:99], v[112:115]
    v_add_u32 v244, s38, v240
    v_add_u32 v246, s38, v242
    ds_read_b128 v[16:19], v244
    v_mfma_f32_16x16x32_bf16 v[116:119], v[64:67], v[100:103], v[116:119]
    ds_read_b128 v[48:51], v246 offset:0
    ds_read_b128 v[52:55], v246 offset:2048
    v_mfma_f32_16x16x32_bf16 v[120:123], v[64:67], v[104:107], v[120:123]
    ds_read_b128 v[56:59], v246 offset:4096
    ds_read_b128 v[60:63], v246 offset:6144
    v_mfma_f32_16x16x32_bf16 v[124:127], v[64:67], v[108:111], v[124:127]
    ds_read_b128 v[20:23], v244 offset:2048
    ds_read_b128 v[24:27], v244 offset:4096
    v_mfma_f32_16x16x32_bf16 v[128:131], v[68:71], v[96:99], v[128:131]
    ds_read_b128 v[28:31], v244 offset:6144
    v_add_u32 v245, s38, v241
    v_mfma_f32_16x16x32_bf16 v[132:135], v[68:71], v[100:103], v[132:135]
    v_add_u32 v247, s38, v243
    s_add_u32 s38, s38, 32768
    v_mfma_f32_16x16x32_bf16 v[136:139], v[68:71], v[104:107], v[136:139]
    s_cmp_ge_u32 s38, 163840
    s_cselect_b32 s38, 0, s38
    v_mfma_f32_16x16x32_bf16 v[140:143], v[68:71], v[108:111], v[140:143]
    v_mfma_f32_16x16x32_bf16 v[144:147], v[72:75], v[96:99], v[144:147]
    v_mfma_f32_16x16x32_bf16 v[148:151], v[72:75], v[100:103], v[148:151]
    v_mfma_f32_16x16x32_bf16 v[152:155], v[72:75], v[104:107], v[152:155]
    v_mfma_f32_16x16x32_bf16 v[156:159], v[72:75], v[108:111], v[156:159]
    v_mfma_f32_16x16x32_bf16 v[160:163], v[76:79], v[96:99], v[160:163]
    v_mfma_f32_16x16x32_bf16 v[164:167], v[76:79], v[100:103], v[164:167]
    v_mfma_f32_16x16x32_bf16 v[168:171], v[76:79], v[104:107], v[168:171]
    v_mfma_f32_16x16x32_bf16 v[172:175], v[76:79], v[108:111], v[172:175]
    s_add_u32 s35, s35, 1
    s_cmp_lt_u32 s35, s65
    s_cbranch_scc1 K2_LOOP
    s_cmp_lg_u32 s35, s36
    s_cbranch_scc1 K2_LAST
    s_nop 7
    v_mul_f32 v176, v112, v248
    v_mul_f32 v177, v113, v248
    v_mul_f32 v178, v114, v248
    v_mul_f32 v179, v115, v248
    v_mul_f32 v180, v116, v249
    v_mul_f32 v181, v117, v249
    v_mul_f32 v182, v118, v249
    v_mul_f32 v183, v119, v249
    v_mul_f32 v184, v120, v250
    v_mul_f32 v185, v121, v250
    v_mul_f32 v186, v122, v250
    v_mul_f32 v187, v123, v250
    v_mul_f32 v188, v124, v251
    v_mul_f32 v189, v125, v251
    v_mul_f32 v190, v126, v251
    v_mul_f32 v191, v127, v251
    v_mul_f32 v192, v128, v248
    v_mul_f32 v193, v129, v248
    v_mul_f32 v194, v130, v248
    v_mul_f32 v195, v131, v248
    v_mul_f32 v196, v132, v249
    v_mul_f32 v197, v133, v249
    v_mul_f32 v198, v134, v249
    v_mul_f32 v199, v135, v249
    v_mul_f32 v200, v136, v250
    v_mul_f32 v201, v137, v250
    v_mul_f32 v202, v138, v250
    v_mul_f32 v203, v139, v250
    v_mul_f32 v204, v140, v251
    v_mul_f32 v205, v141, v251
    v_mul_f32 v206, v142, v251
    v_mul_f32 v207, v143, v251
    v_mul_f32 v208, v144, v248
    v_mul_f32 v209, v145, v248
    v_mul_f32 v210, v146, v248
    v_mul_f32 v211, v147, v248
    v_mul_f32 v212, v148, v249
    v_mul_f32 v213, v149, v249
    v_mul_f32 v214, v150, v249
    v_mul_f32 v215, v151, v249
    v_mul_f32 v216, v152, v250
    v_mul_f32 v217, v153, v250
    v_mul_f32 v218, v154, v250
    v_mul_f32 v219, v155, v250
    v_mul_f32 v220, v156, v251
    v_mul_f32 v221, v157, v251
    v_mul_f32 v222, v158, v251
    v_mul_f32 v223, v159, v251
    v_mul_f32 v224, v160, v248
    v_mul_f32 v225, v161, v248
    v_mul_f32 v226, v162, v248
    v_mul_f32 v227, v163, v248
    v_mul_f32 v228, v164, v249
    v_mul_f32 v229, v165, v249
    v_mul_f32 v230, v166, v249
    v_mul_f32 v231, v167, v249
    v_mul_f32 v232, v168, v250
    v_mul_f32 v233, v169, v250
    v_mul_f32 v234, v170, v250
    v_mul_f32 v235, v171, v250
    v_mul_f32 v236, v172, v251
    v_mul_f32 v237, v173, v251
    v_mul_f32 v238, v174, v251
    v_mul_f32 v239, v175, v251
    v_mov_b32 v112, 0
    v_mov_b32 v113, 0
    v_mov_b32 v114, 0
    v_mov_b32 v115, 0
    v_mov_b32 v116, 0
    v_mov_b32 v117, 0
    v_mov_b32 v118, 0
    v_mov_b32 v119, 0
    v_mov_b32 v120, 0
    v_mov_b32 v121, 0
    v_mov_b32 v122, 0
    v_mov_b32 v123, 0
    v_mov_b32 v124, 0
    v_mov_b32 v125, 0
    v_mov_b32 v126, 0
    v_mov_b32 v127, 0
    v_mov_b32 v128, 0
    v_mov_b32 v129, 0
    v_mov_b32 v130, 0
    v_mov_b32 v131, 0
    v_mov_b32 v132, 0
    v_mov_b32 v133, 0
    v_mov_b32 v134, 0
    v_mov_b32 v135, 0
    v_mov_b32 v136, 0
    v_mov_b32 v137, 0
    v_mov_b32 v138, 0
    v_mov_b32 v139, 0
    v_mov_b32 v140, 0
    v_mov_b32 v141, 0
    v_mov_b32 v142, 0
    v_mov_b32 v143, 0
    v_mov_b32 v144, 0
    v_mov_b32 v145, 0
    v_mov_b32 v146, 0
    v_mov_b32 v147, 0
    v_mov_b32 v148, 0
    v_mov_b32 v149, 0
    v_mov_b32 v150, 0
    v_mov_b32 v151, 0
    v_mov_b32 v152, 0
    v_mov_b32 v153, 0
    v_mov_b32 v154, 0
    v_mov_b32 v155, 0
    v_mov_b32 v156, 0
    v_mov_b32 v157, 0
    v_mov_b32 v158, 0
    v_mov_b32 v159, 0
    v_mov_b32 v160, 0
    v_mov_b32 v161, 0
    v_mov_b32 v162, 0
    v_mov_b32 v163, 0
    v_mov_b32 v164, 0
    v_mov_b32 v165, 0
    v_mov_b32 v166, 0
    v_mov_b32 v167, 0
    v_mov_b32 v168, 0
    v_mov_b32 v169, 0
    v_mov_b32 v170, 0
    v_mov_b32 v171, 0
    v_mov_b32 v172, 0
    v_mov_b32 v173, 0
    v_mov_b32 v174, 0
    v_mov_b32 v175, 0
    s_nop 1
K2_LAST:
    s_waitcnt lgkmcnt(0)
    v_mfma_f32_16x16x32_bf16 v[112:115], v[16:19], v[48:51], v[112:115]
    ds_read_b128 v[64:67], v245
    v_mfma_f32_16x16x32_bf16 v[116:119], v[16:19], v[52:55], v[116:119]
    ds_read_b128 v[96:99], v247 offset:0
    v_mfma_f32_16x16x32_bf16 v[120:123], v[16:19], v[56:59], v[120:123]
    ds_read_b128 v[100:103], v247 offset:2048
    v_mfma_f32_16x16x32_bf16 v[124:127], v[16:19], v[60:63], v[124:127]
    ds_read_b128 v[104:107], v247 offset:4096
    v_mfma_f32_16x16x32_bf16 v[128:131], v[20:23], v[48:51], v[128:131]
    ds_read_b128 v[108:111], v247 offset:6144
    v_mfma_f32_16x16x32_bf16 v[132:135], v[20:23], v[52:55], v[132:135]
    ds_read_b128 v[68:71], v245 offset:2048
    v_mfma_f32_16x16x32_bf16 v[136:139], v[20:23], v[56:59], v[136:139]
    ds_read_b128 v[72:75], v245 offset:4096
    v_mfma_f32_16x16x32_bf16 v[140:143], v[20:23], v[60:63], v[140:143]
    ds_read_b128 v[76:79], v245 offset:6144
    v_mfma_f32_16x16x32_bf16 v[144:147], v[24:27], v[48:51], v[144:147]
    v_mfma_f32_16x16x32_bf16 v[148:151], v[24:27], v[52:55], v[148:151]
    v_mfma_f32_16x16x32_bf16 v[152:155], v[24:27], v[56:59], v[152:155]
    v_mfma_f32_16x16x32_bf16 v[156:159], v[24:27], v[60:63], v[156:159]
    v_mfma_f32_16x16x32_bf16 v[160:163], v[28:31], v[48:51], v[160:163]
    v_mfma_f32_16x16x32_bf16 v[164:167], v[28:31], v[52:55], v[164:167]
    v_mfma_f32_16x16x32_bf16 v[168:171], v[28:31], v[56:59], v[168:171]
    v_mfma_f32_16x16x32_bf16 v[172:175], v[28:31], v[60:63], v[172:175]
    s_waitcnt lgkmcnt(0)
    v_mfma_f32_16x16x32_bf16 v[112:115], v[64:67], v[96:99], v[112:115]
    v_mfma_f32_16x16x32_bf16 v[116:119], v[64:67], v[100:103], v[116:119]
    v_mfma_f32_16x16x32_bf16 v[120:123], v[64:67], v[104:107], v[120:123]
    v_mfma_f32_16x16x32_bf16 v[124:127], v[64:67], v[108:111], v[124:127]
    v_mfma_f32_16x16x32_bf16 v[128:131], v[68:71], v[96:99], v[128:131]
    v_mfma_f32_16x16x32_bf16 v[132:135], v[68:71], v[100:103], v[132:135]
    v_mfma_f32_16x16x32_bf16 v[136:139], v[68:71], v[104:107], v[136:139]
    v_mfma_f32_16x16x32_bf16 v[140:143], v[68:71], v[108:111], v[140:143]
    v_mfma_f32_16x16x32_bf16 v[144:147], v[72:75], v[96:99], v[144:147]
    v_mfma_f32_16x16x32_bf16 v[148:151], v[72:75], v[100:103], v[148:151]
    v_mfma_f32_16x16x32_bf16 v[152:155], v[72:75], v[104:107], v[152:155]
    v_mfma_f32_16x16x32_bf16 v[156:159], v[72:75], v[108:111], v[156:159]
    v_mfma_f32_16x16x32_bf16 v[160:163], v[76:79], v[96:99], v[160:163]
    v_mfma_f32_16x16x32_bf16 v[164:167], v[76:79], v[100:103], v[164:167]
    v_mfma_f32_16x16x32_bf16 v[168:171], v[76:79], v[104:107], v[168:171]
    v_mfma_f32_16x16x32_bf16 v[172:175], v[76:79], v[108:111], v[172:175]
    s_branch K2_EPI
K2_BND:
    s_nop 7
    v_mul_f32 v176, v112, v248
    v_mul_f32 v177, v113, v248
    v_mul_f32 v178, v114, v248
    v_mul_f32 v179, v115, v248
    v_mul_f32 v180, v116, v249
    v_mul_f32 v181, v117, v249
    v_mul_f32 v182, v118, v249
    v_mul_f32 v183, v119, v249
    v_mul_f32 v184, v120, v250
    v_mul_f32 v185, v121, v250
    v_mul_f32 v186, v122, v250
    v_mul_f32 v187, v123, v250
    v_mul_f32 v188, v124, v251
    v_mul_f32 v189, v125, v251
    v_mul_f32 v190, v126, v251
    v_mul_f32 v191, v127, v251
    v_mul_f32 v192, v128, v248
    v_mul_f32 v193, v129, v248
    v_mul_f32 v194, v130, v248
    v_mul_f32 v195, v131, v248
    v_mul_f32 v196, v132, v249
    v_mul_f32 v197, v133, v249
    v_mul_f32 v198, v134, v249
    v_mul_f32 v199, v135, v249
    v_mul_f32 v200, v136, v250
    v_mul_f32 v201, v137, v250
    v_mul_f32 v202, v138, v250
    v_mul_f32 v203, v139, v250
    v_mul_f32 v204, v140, v251
    v_mul_f32 v205, v141, v251
    v_mul_f32 v206, v142, v251
    v_mul_f32 v207, v143, v251
    v_mul_f32 v208, v144, v248
    v_mul_f32 v209, v145, v248
    v_mul_f32 v210, v146, v248
    v_mul_f32 v211, v147, v248
    v_mul_f32 v212, v148, v249
    v_mul_f32 v213, v149, v249
    v_mul_f32 v214, v150, v249
    v_mul_f32 v215, v151, v249
    v_mul_f32 v216, v152, v250
    v_mul_f32 v217, v153, v250
    v_mul_f32 v218, v154, v250
    v_mul_f32 v219, v155, v250
    v_mul_f32 v220, v156, v251
    v_mul_f32 v221, v157, v251
    v_mul_f32 v222, v158, v251
    v_mul_f32 v223, v159, v251
    v_mul_f32 v224, v160, v248
    v_mul_f32 v225, v161, v248
    v_mul_f32 v226, v162, v248
    v_mul_f32 v227, v163, v248
    v_mul_f32 v228, v164, v249
    v_mul_f32 v229, v165, v249
    v_mul_f32 v230, v166, v249
    v_mul_f32 v231, v167, v249
    v_mul_f32 v232, v168, v250
    v_mul_f32 v233, v169, v250
    v_mul_f32 v234, v170, v250
    v_mul_f32 v235, v171, v250
    v_mul_f32 v236, v172, v251
    v_mul_f32 v237, v173, v251
    v_mul_f32 v238, v174, v251
    v_mul_f32 v239, v175, v251
    v_mov_b32 v112, 0
    v_mov_b32 v113, 0
    v_mov_b32 v114, 0
    v_mov_b32 v115, 0
    v_mov_b32 v116, 0
    v_mov_b32 v117, 0
    v_mov_b32 v118, 0
    v_mov_b32 v119, 0
    v_mov_b32 v120, 0
    v_mov_b32 v121, 0
    v_mov_b32 v122, 0
    v_mov_b32 v123, 0
    v_mov_b32 v124, 0
    v_mov_b32 v125, 0
    v_mov_b32 v126, 0
    v_mov_b32 v127, 0
    v_mov_b32 v128, 0
    v_mov_b32 v129, 0
    v_mov_b32 v130, 0
    v_mov_b32 v131, 0
    v_mov_b32 v132, 0
    v_mov_b32 v133, 0
    v_mov_b32 v134, 0
    v_mov_b32 v135, 0
    v_mov_b32 v136, 0
    v_mov_b32 v137, 0
    v_mov_b32 v138, 0
    v_mov_b32 v139, 0
    v_mov_b32 v140, 0
    v_mov_b32 v141, 0
    v_mov_b32 v142, 0
    v_mov_b32 v143, 0
    v_mov_b32 v144, 0
    v_mov_b32 v145, 0
    v_mov_b32 v146, 0
    v_mov_b32 v147, 0
    v_mov_b32 v148, 0
    v_mov_b32 v149, 0
    v_mov_b32 v150, 0
    v_mov_b32 v151, 0
    v_mov_b32 v152, 0
    v_mov_b32 v153, 0
    v_mov_b32 v154, 0
    v_mov_b32 v155, 0
    v_mov_b32 v156, 0
    v_mov_b32 v157, 0
    v_mov_b32 v158, 0
    v_mov_b32 v159, 0
    v_mov_b32 v160, 0
    v_mov_b32 v161, 0
    v_mov_b32 v162, 0
    v_mov_b32 v163, 0
    v_mov_b32 v164, 0
    v_mov_b32 v165, 0
    v_mov_b32 v166, 0
    v_mov_b32 v167, 0
    v_mov_b32 v168, 0
    v_mov_b32 v169, 0
    v_mov_b32 v170, 0
    v_mov_b32 v171, 0
    v_mov_b32 v172, 0
    v_mov_b32 v173, 0
    v_mov_b32 v174, 0
    v_mov_b32 v175, 0
    s_nop 1
    s_branch K2_BACK
K2_EPI:
    s_nop 7
    v_sub_f32 v252, 1.0, v248
    v_sub_f32 v253, 1.0, v249
    v_sub_f32 v254, 1.0, v250
    v_sub_f32 v255, 1.0, v251
    s_cmp_eq_u32 s36, s31
    s_cselect_b64 vcc, -1, 0
    s_nop 1
    v_cndmask_b32 v252, v252, v248, vcc
    v_cndmask_b32 v253, v253, v249, vcc
    v_cndmask_b32 v254, v254, v250, vcc
    v_cndmask_b32 v255, v255, v251, vcc
    v_fma_f32 v112, v112, v252, v176
    v_fma_f32 v113, v113, v252, v177
    v_fma_f32 v114, v114, v252, v178
    v_fma_f32 v115, v115, v252, v179
    v_fma_f32 v116, v116, v253, v180
    v_fma_f32 v117, v117, v253, v181
    v_fma_f32 v118, v118, v253, v182
    v_fma_f32 v119, v119, v253, v183
    v_fma_f32 v120, v120, v254, v184
    v_fma_f32 v121, v121, v254, v185
    v_fma_f32 v122, v122, v254, v186
    v_fma_f32 v123, v123, v254, v187
    v_fma_f32 v124, v124, v255, v188
    v_fma_f32 v125, v125, v255, v189
    v_fma_f32 v126, v126, v255, v190
    v_fma_f32 v127, v127, v255, v191
    v_fma_f32 v128, v128, v252, v192
    v_fma_f32 v129, v129, v252, v193
    v_fma_f32 v130, v130, v252, v194
    v_fma_f32 v131, v131, v252, v195
    v_fma_f32 v132, v132, v253, v196
    v_fma_f32 v133, v133, v253, v197
    v_fma_f32 v134, v134, v253, v198
    v_fma_f32 v135, v135, v253, v199
    v_fma_f32 v136, v136, v254, v200
    v_fma_f32 v137, v137, v254, v201
    v_fma_f32 v138, v138, v254, v202
    v_fma_f32 v139, v139, v254, v203
    v_fma_f32 v140, v140, v255, v204
    v_fma_f32 v141, v141, v255, v205
    v_fma_f32 v142, v142, v255, v206
    v_fma_f32 v143, v143, v255, v207
    v_fma_f32 v144, v144, v252, v208
    v_fma_f32 v145, v145, v252, v209
    v_fma_f32 v146, v146, v252, v210
    v_fma_f32 v147, v147, v252, v211
    v_fma_f32 v148, v148, v253, v212
    v_fma_f32 v149, v149, v253, v213
    v_fma_f32 v150, v150, v253, v214
    v_fma_f32 v151, v151, v253, v215
    v_fma_f32 v152, v152, v254, v216
    v_fma_f32 v153, v153, v254, v217
    v_fma_f32 v154, v154, v254, v218
    v_fma_f32 v155, v155, v254, v219
    v_fma_f32 v156, v156, v255, v220
    v_fma_f32 v157, v157, v255, v221
    v_fma_f32 v158, v158, v255, v222
    v_fma_f32 v159, v159, v255, v223
    v_fma_f32 v160, v160, v252, v224
    v_fma_f32 v161, v161, v252, v225
    v_fma_f32 v162, v162, v252, v226
    v_fma_f32 v163, v163, v252, v227
    v_fma_f32 v164, v164, v253, v228
    v_fma_f32 v165, v165, v253, v229
    v_fma_f32 v166, v166, v253, v230
    v_fma_f32 v167, v167, v253, v231
    v_fma_f32 v168, v168, v254, v232
    v_fma_f32 v169, v169, v254, v233
    v_fma_f32 v170, v170, v254, v234
    v_fma_f32 v171, v171, v254, v235
    v_fma_f32 v172, v172, v255, v236
    v_fma_f32 v173, v173, v255, v237
    v_fma_f32 v174, v174, v255, v238
    v_fma_f32 v175, v175, v255, v239
    s_lshl_b32 s28, s33, 2
    s_add_u32 s28, s28, s32
    s_lshl_b32 s66, s28, 2
    s_add_u32 s66, s66, s24
    v_lshlrev_b32 v4, 4, v2
    s_lshl_b32 s28, s25, 8
    s_add_u32 s28, s28, s66
    s_lshl_b32 s28, s28, 11
    v_add_u32 v5, s28, v4
    s_cmp_eq_u32 s25, 0
    s_cbranch_scc1 K2X_1
    v_cvt_pk_bf16_f32 v16, v112, v113
    v_cvt_pk_bf16_f32 v17, v114, v115
    v_cvt_pk_bf16_f32 v18, v116, v117
    v_cvt_pk_bf16_f32 v19, v118, v119
    v_cvt_pk_bf16_f32 v20, v120, v121
    v_cvt_pk_bf16_f32 v21, v122, v123
    v_cvt_pk_bf16_f32 v22, v124, v125
    v_cvt_pk_bf16_f32 v23, v126, v127
    s_mov_b32 s29, 0x0
    buffer_store_dwordx4 v[16:19], v5, s[20:23], s29 offen offset:0 sc0 sc1
    buffer_store_dwordx4 v[20:23], v5, s[20:23], s29 offen offset:1024 sc0 sc1
K2X_1:
    s_cmp_eq_u32 s25, 1
    s_cbranch_scc1 K2X_2
    v_cvt_pk_bf16_f32 v24, v128, v129
    v_cvt_pk_bf16_f32 v25, v130, v131
    v_cvt_pk_bf16_f32 v26, v132, v133
    v_cvt_pk_bf16_f32 v27, v134, v135
    v_cvt_pk_bf16_f32 v28, v136, v137
    v_cvt_pk_bf16_f32 v29, v138, v139
    v_cvt_pk_bf16_f32 v30, v140, v141
    v_cvt_pk_bf16_f32 v31, v142, v143
    s_mov_b32 s29, 0x200000
    buffer_store_dwordx4 v[24:27], v5, s[20:23], s29 offen offset:0 sc0 sc1
    buffer_store_dwordx4 v[28:31], v5, s[20:23], s29 offen offset:1024 sc0 sc1
K2X_2:
    s_cmp_eq_u32 s25, 2
    s_cbranch_scc1 K2X_3
    v_cvt_pk_bf16_f32 v32, v144, v145
    v_cvt_pk_bf16_f32 v33, v146, v147
    v_cvt_pk_bf16_f32 v34, v148, v149
    v_cvt_pk_bf16_f32 v35, v150, v151
    v_cvt_pk_bf16_f32 v36, v152, v153
    v_cvt_pk_bf16_f32 v37, v154, v155
    v_cvt_pk_bf16_f32 v38, v156, v157
    v_cvt_pk_bf16_f32 v39, v158, v159
    s_mov_b32 s29, 0x400000
    buffer_store_dwordx4 v[32:35], v5, s[20:23], s29 offen offset:0 sc0 sc1
    buffer_store_dwordx4 v[36:39], v5, s[20:23], s29 offen offset:1024 sc0 sc1
K2X_3:
    s_cmp_eq_u32 s25, 3
    s_cbranch_scc1 K2X_4
    v_cvt_pk_bf16_f32 v40, v160, v161
    v_cvt_pk_bf16_f32 v41, v162, v163
    v_cvt_pk_bf16_f32 v42, v164, v165
    v_cvt_pk_bf16_f32 v43, v166, v167
    v_cvt_pk_bf16_f32 v44, v168, v169
    v_cvt_pk_bf16_f32 v45, v170, v171
    v_cvt_pk_bf16_f32 v46, v172, v173
    v_cvt_pk_bf16_f32 v47, v174, v175
    s_mov_b32 s29, 0x600000
    buffer_store_dwordx4 v[40:43], v5, s[20:23], s29 offen offset:0 sc0 sc1
    buffer_store_dwordx4 v[44:47], v5, s[20:23], s29 offen offset:1024 sc0 sc1
K2X_4:
    s_cmp_lg_u32 s25, 0
    s_cbranch_scc1 K2M_5
    v_mov_b32 v56, v112
    v_mov_b32 v57, v113
    v_mov_b32 v58, v114
    v_mov_b32 v59, v115
    v_mov_b32 v60, v116
    v_mov_b32 v61, v117
    v_mov_b32 v62, v118
    v_mov_b32 v63, v119
    v_mov_b32 v64, v120
    v_mov_b32 v65, v121
    v_mov_b32 v66, v122
    v_mov_b32 v67, v123
    v_mov_b32 v68, v124
    v_mov_b32 v69, v125
    v_mov_b32 v70, v126
    v_mov_b32 v71, v127
K2M_5:
    s_cmp_lg_u32 s25, 1
    s_cbranch_scc1 K2M_6
    v_mov_b32 v56, v128
    v_mov_b32 v57, v129
    v_mov_b32 v58, v130
    v_mov_b32 v59, v131
    v_mov_b32 v60, v132
    v_mov_b32 v61, v133
    v_mov_b32 v62, v134
    v_mov_b32 v63, v135
    v_mov_b32 v64, v136
    v_mov_b32 v65, v137
    v_mov_b32 v66, v138
    v_mov_b32 v67, v139
    v_mov_b32 v68, v140
    v_mov_b32 v69, v141
    v_mov_b32 v70, v142
    v_mov_b32 v71, v143
K2M_6:
    s_cmp_lg_u32 s25, 2
    s_cbranch_scc1 K2M_7
    v_mov_b32 v56, v144
    v_mov_b32 v57, v145
    v_mov_b32 v58, v146
    v_mov_b32 v59, v147
    v_mov_b32 v60, v148
    v_mov_b32 v61, v149
    v_mov_b32 v62, v150
    v_mov_b32 v63, v151
    v_mov_b32 v64, v152
    v_mov_b32 v65, v153
    v_mov_b32 v66, v154
    v_mov_b32 v67, v155
    v_mov_b32 v68, v156
    v_mov_b32 v69, v157
    v_mov_b32 v70, v158
    v_mov_b32 v71, v159
K2M_7:
    s_cmp_lg_u32 s25, 3
    s_cbranch_scc1 K2M_8
    v_mov_b32 v56, v160
    v_mov_b32 v57, v161
    v_mov_b32 v58, v162
    v_mov_b32 v59, v163
    v_mov_b32 v60, v164
    v_mov_b32 v61, v165
    v_mov_b32 v62, v166
    v_mov_b32 v63, v167
    v_mov_b32 v64, v168
    v_mov_b32 v65, v169
    v_mov_b32 v66, v170
    v_mov_b32 v67, v171
    v_mov_b32 v68, v172
    v_mov_b32 v69, v173
    v_mov_b32 v70, v174
    v_mov_b32 v71, v175
K2M_8:
    s_waitcnt vmcnt(0)
    s_lshl_b32 s28, s66, 7
    s_lshl_b32 s29, s25, 2
    s_add_u32 s29, s29, s28
    v_mov_b32 v6, s29
    v_mov_b32 v7, s28
    v_mov_b32 v16, 1
    v_cmp_eq_u32 vcc, 0, v2
    s_and_saveexec_b64 s[58:59], vcc
    buffer_store_dword v16, v6, s[52:55], 0 offen sc0 sc1
    s_mov_b64 exec, s[58:59]
    s_lshl_b32 s28, s25, 21
    s_lshl_b32 s29, s66, 11
    s_add_u32 s28, s28, s29
    v_add_u32 v5, s28, v4
    v_and_b32 v4, 15, v2
    v_add_u32 v4, s64, v4
    v_lshlrev_b32 v4, 10, v4
    v_lshrrev_b32 v6, 4, v2
    v_lshlrev_b32 v6, 3, v6
    s_lshl_b32 s28, s32, 8
    s_lshr_b32 s29, s24, 1
    s_lshl_b32 s29, s29, 7
    s_add_u32 s28, s28, s29
    s_lshl_b32 s29, s25, 5
    s_add_u32 s28, s28, s29
    v_add3_u32 v4, v4, v6, s28
    s_mov_b32 s56, s62
    s_mov_b32 s57, s63
    s_and_b32 s57, s57, 0xffff
    s_mov_b32 s58, 0x200000
    s_mov_b32 s59, 0x00020000
    s_mov_b32 s35, 0
K2_POLL:
    buffer_load_dwordx4 v[20:23], v7, s[52:55], 0 offen sc0 sc1
    s_waitcnt vmcnt(0)
    v_and_b32 v20, v20, v21
    v_and_b32 v22, v22, v23
    v_and_b32 v20, v20, v22
    s_nop 0
    v_readfirstlane_b32 s28, v20
    s_add_u32 s35, s35, 1
    s_cmp_eq_u32 s28, 1
    s_cbranch_scc1 K2_GO
    s_cmp_lt_u32 s35, 0x40000
    s_cbranch_scc1 K2_POLL
K2_GO:
    s_add_u32 s29, s25, 1
    s_and_b32 s29, s29, 3
    s_lshl_b32 s29, s29, 19
    buffer_load_dwordx4 v[112:115], v5, s[20:23], s29 offen offset:0 sc0 sc1
    buffer_load_dwordx4 v[116:119], v5, s[20:23], s29 offen offset:1024 sc0 sc1
    s_add_u32 s29, s25, 2
    s_and_b32 s29, s29, 3
    s_lshl_b32 s29, s29, 19
    buffer_load_dwordx4 v[120:123], v5, s[20:23], s29 offen offset:0 sc0 sc1
    buffer_load_dwordx4 v[124:127], v5, s[20:23], s29 offen offset:1024 sc0 sc1
    s_add_u32 s29, s25, 3
    s_and_b32 s29, s29, 3
    s_lshl_b32 s29, s29, 19
    buffer_load_dwordx4 v[128:131], v5, s[20:23], s29 offen offset:0 sc0 sc1
    buffer_load_dwordx4 v[132:135], v5, s[20:23], s29 offen offset:1024 sc0 sc1
    s_waitcnt vmcnt(4)
    v_lshlrev_b32 v16, 16, v112
    v_and_b32 v17, 0xffff0000, v112
    v_add_f32 v56, v56, v16
    v_add_f32 v57, v57, v17
    v_lshlrev_b32 v18, 16, v113
    v_and_b32 v19, 0xffff0000, v113
    v_add_f32 v58, v58, v18
    v_add_f32 v59, v59, v19
    v_lshlrev_b32 v20, 16, v114
    v_and_b32 v21, 0xffff0000, v114
    v_add_f32 v60, v60, v20
    v_add_f32 v61, v61, v21
    v_lshlrev_b32 v22, 16, v115
    v_and_b32 v23, 0xffff0000, v115
    v_add_f32 v62, v62, v22
    v_add_f32 v63, v63, v23
    v_lshlrev_b32 v16, 16, v116
    v_and_b32 v17, 0xffff0000, v116
    v_add_f32 v64, v64, v16
    v_add_f32 v65, v65, v17
    v_lshlrev_b32 v18, 16, v117
    v_and_b32 v19, 0xffff0000, v117
    v_add_f32 v66, v66, v18
    v_add_f32 v67, v67, v19
    v_lshlrev_b32 v20, 16, v118
    v_and_b32 v21, 0xffff0000, v118
    v_add_f32 v68, v68, v20
    v_add_f32 v69, v69, v21
    v_lshlrev_b32 v22, 16, v119
    v_and_b32 v23, 0xffff0000, v119
    v_add_f32 v70, v70, v22
    v_add_f32 v71, v71, v23
    s_waitcnt vmcnt(2)
    v_lshlrev_b32 v16, 16, v120
    v_and_b32 v17, 0xffff0000, v120
    v_add_f32 v56, v56, v16
    v_add_f32 v57, v57, v17
    v_lshlrev_b32 v18, 16, v121
    v_and_b32 v19, 0xffff0000, v121
    v_add_f32 v58, v58, v18
    v_add_f32 v59, v59, v19
    v_lshlrev_b32 v20, 16, v122
    v_and_b32 v21, 0xffff0000, v122
    v_add_f32 v60, v60, v20
    v_add_f32 v61, v61, v21
    v_lshlrev_b32 v22, 16, v123
    v_and_b32 v23, 0xffff0000, v123
    v_add_f32 v62, v62, v22
    v_add_f32 v63, v63, v23
    v_lshlrev_b32 v16, 16, v124
    v_and_b32 v17, 0xffff0000, v124
    v_add_f32 v64, v64, v16
    v_add_f32 v65, v65, v17
    v_lshlrev_b32 v18, 16, v125
    v_and_b32 v19, 0xffff0000, v125
    v_add_f32 v66, v66, v18
    v_add_f32 v67, v67, v19
    v_lshlrev_b32 v20, 16, v126
    v_and_b32 v21, 0xffff0000, v126
    v_add_f32 v68, v68, v20
    v_add_f32 v69, v69, v21
    v_lshlrev_b32 v22, 16, v127
    v_and_b32 v23, 0xffff0000, v127
    v_add_f32 v70, v70, v22
    v_add_f32 v71, v71, v23
    s_waitcnt vmcnt(0)
    v_lshlrev_b32 v16, 16, v128
    v_and_b32 v17, 0xffff0000, v128
    v_add_f32 v56, v56, v16
    v_add_f32 v57, v57, v17
    v_lshlrev_b32 v18, 16, v129
    v_and_b32 v19, 0xffff0000, v129
    v_add_f32 v58, v58, v18
    v_add_f32 v59, v59, v19
    v_lshlrev_b32 v20, 16, v130
    v_and_b32 v21, 0xffff0000, v130
    v_add_f32 v60, v60, v20
    v_add_f32 v61, v61, v21
    v_lshlrev_b32 v22, 16, v131
    v_and_b32 v23, 0xffff0000, v131
    v_add_f32 v62, v62, v22
    v_add_f32 v63, v63, v23
    v_lshlrev_b32 v16, 16, v132
    v_and_b32 v17, 0xffff0000, v132
    v_add_f32 v64, v64, v16
    v_add_f32 v65, v65, v17
    v_lshlrev_b32 v18, 16, v133
    v_and_b32 v19, 0xffff0000, v133
    v_add_f32 v66, v66, v18
    v_add_f32 v67, v67, v19
    v_lshlrev_b32 v20, 16, v134
    v_and_b32 v21, 0xffff0000, v134
    v_add_f32 v68, v68, v20
    v_add_f32 v69, v69, v21
    v_lshlrev_b32 v22, 16, v135
    v_and_b32 v23, 0xffff0000, v135
    v_add_f32 v70, v70, v22
    v_add_f32 v71, v71, v23
    v_cvt_pk_bf16_f32 v16, v56, v57
    v_cvt_pk_bf16_f32 v17, v58, v59
    v_cvt_pk_bf16_f32 v18, v60, v61
    v_cvt_pk_bf16_f32 v19, v62, v63
    v_cvt_pk_bf16_f32 v20, v64, v65
    v_cvt_pk_bf16_f32 v21, v66, v67
    v_cvt_pk_bf16_f32 v22, v68, v69
    v_cvt_pk_bf16_f32 v23, v70, v71
    s_mov_b32 s29, 0
    buffer_store_dwordx2 v[16:17], v4, s[56:59], s29 offen
    s_mov_b32 s29, 16384
    buffer_store_dwordx2 v[18:19], v4, s[56:59], s29 offen
    s_mov_b32 s29, 32768
    buffer_store_dwordx2 v[20:21], v4, s[56:59], s29 offen
    s_mov_b32 s29, 49152
    buffer_store_dwordx2 v[22:23], v4, s[56:59], s29 offen
K2_END:
    s_endpgm
.section .rodata,"a"
.p2align 6
.amdhsa_kernel k1_kernel
  .amdhsa_next_free_vgpr 256
  .amdhsa_next_free_sgpr 102
  .amdhsa_accum_offset 256
  .amdhsa_group_segment_fixed_size 0
  .amdhsa_kernarg_size 104
  .amdhsa_user_sgpr_count 2
  .amdhsa_user_sgpr_kernarg_segment_ptr 1
  .amdhsa_system_sgpr_workgroup_id_x 1
.end_amdhsa_kernel

.p2align 6
.amdhsa_kernel k2_kernel
  .amdhsa_next_free_vgpr 256
  .amdhsa_next_free_sgpr 102
  .amdhsa_accum_offset 256
  .amdhsa_group_segment_fixed_size 0
  .amdhsa_kernarg_size 104
  .amdhsa_user_sgpr_count 2
  .amdhsa_user_sgpr_kernarg_segment_ptr 1
  .amdhsa_system_sgpr_workgroup_id_x 1
.end_amdhsa_kernel
```
